```python
import torch

def _softmax(x, axis=-1):
    return torch.softmax(x, dim=axis)
def _gelu(x):
    return torch.nn.functional.gelu(x, approximate="tanh")
def _silu(x):
    return torch.nn.functional.silu(x)
def _sigmoid(x):
    return torch.sigmoid(x)
def _layernorm(x, axis=-1, eps=1e-5):
    m = x.mean(dim=axis, keepdim=True)
    v = x.var(dim=axis, keepdim=True, unbiased=False)
    return (x - m) / torch.sqrt(v + eps)
def _scatter_add(tgt, idx, src, axis=0):
    return tgt.clone().index_add_(axis, idx, src)
def _segment_sum(src, seg, n):
    out = torch.zeros((n,) + src.shape[1:], dtype=src.dtype)
    return out.index_add_(0, seg, src)
def _pad(x, pw):
    flat = tuple(v for pair in reversed(pw) for v in pair)
    return torch.nn.functional.pad(x, flat)

kernel_name = 'standalone__mpnn_edge_mlp__graph'

def setup_inputs():

    _w = (lambda a: (lambda t: t.to(torch.bfloat16) if t.is_floating_point() else t)(torch.as_tensor(a)))
    N, deg, D, De = 10000, 16, 256, max(4, 1)
    E = N * deg
    return {
        "x": _w((lambda *s: torch.randn(*s, dtype=torch.bfloat16) * 0.05)(N, D)),
        "e_attr": _w((lambda *s: torch.randn(*s, dtype=torch.bfloat16) * 0.4)(E, De)),
        "src": _w((lambda lo, hi, *s: torch.randint(lo, hi, s))(0, N, E).to(torch.int64)),
        "dst": _w((lambda lo, hi, *s: torch.randint(lo, hi, s))(0, N, E).to(torch.int64)),
        "w_msg": _w((lambda *s: torch.randn(*s, dtype=torch.bfloat16) * 0.4)(2 * D + De, D)),
        "w_upd": _w((lambda *s: torch.randn(*s, dtype=torch.bfloat16) * 0.05)(2 * D, D)),
    }

def reference(x, e_attr, src, dst, w_msg, w_upd):
    N, D = x.shape
    m_in = torch.concatenate([x[src], x[dst], e_attr], axis=-1)
    msg = _silu(m_in @ w_msg)
    agg = _segment_sum(msg, dst, N)
    return _silu(torch.concatenate([x, agg], axis=-1) @ w_upd)
```

```asm
; @launch grid=(256,1,1) block=(512,1,1) lds=163840
.amdgcn_target "amdgcn-amd-amdhsa--gfx950"
.text
.globl standalone__mpnn_edge_mlp__graph_kernel
.p2align 8
.type standalone__mpnn_edge_mlp__graph_kernel,@function
standalone__mpnn_edge_mlp__graph_kernel:
    s_cmp_ge_u32 s2, 256
    s_cbranch_scc1 k2_done
    s_load_dwordx4 s[12:15], s[0:1], 32
    s_load_dwordx4 s[8:11], s[0:1], 16
    s_load_dwordx4 s[4:7], s[0:1], 0
    s_load_dwordx4 s[16:19], s[0:1], 48
    s_load_dwordx2 s[32:33], s[0:1], 64
    v_lshrrev_b32 v108, 6, v0
    v_and_b32 v1, 63, v0
    v_readfirstlane_b32 s44, v108
    v_lshlrev_b32 v3, 4, v1
    s_cmp_lg_u32 s44, 3
    s_cbranch_scc1 kf_noct
    s_getpc_b64 s[74:75]
    kf_pc:
    s_and_b32 s57, s2, 0xf8
    s_lshl_b32 s57, s57, 7
    s_min_u32 s57, s57, k2_done-kf_pc-1024
    s_add_u32 s74, s74, s57
    s_addc_u32 s75, s75, 0
    global_load_dwordx4 v[58:61], v3, s[74:75]
    kf_noct:
    v_lshlrev_b32 v111, 4, v0
    s_mul_i32 s98, s2, 625
    s_bfe_u32 s57, s2, 0x50003
    s_lshl_b32 s57, s57, 13
    s_lshl_b32 s51, s98, 2
    s_lshl_b32 s52, s98, 3
    s_and_b32 s49, s2, 7
    s_lshl_b32 s49, s49, 5
    s_lshr_b32 s55, s2, 3
    s_or_b32 s49, s49, s55
    s_mul_i32 s98, s49, 625
    s_add_u32 s3, s98, 640
    s_add_u32 s98, s98, 15
    s_lshr_b32 s98, s98, 4
    s_lshr_b32 s3, s3, 4
    s_sub_u32 s3, s3, s98
    s_lshr_b32 s45, s44, 2
    s_and_b32 s46, s44, 3
    s_lshl_b32 s99, s44, 14
    s_add_u32 s99, s99, 2883584
    v_lshrrev_b32 v108, 5, v1
    v_and_b32 v109, 31, v1
    s_lshl_b32 s55, s44, 1
    v_xor_b32 v110, v109, v108
    v_xor_b32 v110, s55, v110
    v_lshlrev_b32 v110, 4, v110
    v_lshl_add_u32 v110, v108, 9, v110
    v_xor_b32 v112, s44, v109
    v_lshlrev_b32 v112, 4, v112
    s_waitcnt lgkmcnt(0)
    s_mov_b32 s0, s49
    s_cmp_lg_u32 s44, 1
    s_cbranch_scc1 kf_noedge
    s_setprio 3
    v_mul_u32_u24 v108, 40, v1
    v_mul_u32_u24 v109, 80, v1
    s_mov_b32 s28, s10
    s_and_b32 s29, s11, 0xffff
    s_mov_b32 s30, 640000
    s_mov_b32 s31, 0x20000
    buffer_load_dwordx4 v[26:29], v108, s[28:31], s51 offen
    buffer_load_dwordx4 v[30:33], v108, s[28:31], s51 offen offset:16
    buffer_load_dwordx2 v[34:35], v108, s[28:31], s51 offen offset:32
    s_mov_b32 s20, s8
    s_and_b32 s21, s9, 0xffff
    s_mov_b32 s22, 640000
    s_mov_b32 s23, 0x20000
    buffer_load_dwordx4 v[36:39], v108, s[20:23], s51 offen
    buffer_load_dwordx4 v[40:43], v108, s[20:23], s51 offen offset:16
    buffer_load_dwordx2 v[44:45], v108, s[20:23], s51 offen offset:32
    s_mov_b32 s36, s6
    s_and_b32 s37, s7, 0xffff
    s_mov_b32 s38, 1280000
    s_mov_b32 s39, 0x20000
    buffer_load_dwordx4 v[46:49], v109, s[36:39], s52 offen offset:0
    buffer_load_dwordx4 v[50:53], v109, s[36:39], s52 offen offset:16
    buffer_load_dwordx4 v[54:57], v109, s[36:39], s52 offen offset:32
    buffer_load_dwordx4 v[58:61], v109, s[36:39], s52 offen offset:48
    buffer_load_dwordx4 v[62:65], v109, s[36:39], s52 offen offset:64
kf_noedge:
    s_cmp_eq_u32 s2, 0
    s_cbranch_scc1 kf_init
kf_noinit:
    s_mov_b32 s68, s12
    s_and_b32 s69, s13, 0xffff
    s_mov_b32 s70, 264192
    s_mov_b32 s71, 0x20000
    buffer_load_dwordx4 v[86:89], v111, s[68:71], s57 offen
    s_cmp_lg_u32 s44, 6
    s_cbranch_scc1 kf_now3
    s_mov_b32 m0, 122880
    s_mov_b32 s55, 262144
    buffer_load_dwordx4 v3, s[68:71], s55 offen lds
    buffer_load_dwordx4 v3, s[68:71], s55 offen offset:1024 lds
kf_now3:
    s_mov_b32 s24, s4
    s_and_b32 s25, s5, 0xffff
    s_mov_b32 s26, 5120000
    s_mov_b32 s27, 0x20000
    s_lshl_b32 s55, s98, 9
    s_lshl_b32 s56, s44, 10
    s_add_u32 s57, s55, s56
    s_add_u32 m0, s56, 126208
    s_lshl_b32 s54, s44, 9
    buffer_load_dwordx4 v110, s[24:27], s57 offen lds
    s_add_u32 m0, s56, 134400
    s_add_u32 s57, s57, 8192
    buffer_load_dwordx4 v110, s[24:27], s57 offen lds
    s_add_u32 m0, s54, 142592
    s_add_u32 s55, s55, s54
    s_add_u32 s55, s55, 16384
    s_mov_b32 exec_hi, 0
    buffer_load_dwordx4 v112, s[24:27], s55 offen lds
    s_mov_b32 exec_hi, -1
    s_add_u32 s64, s32, 4096
    s_addc_u32 s65, s33, 0
    s_and_b32 s65, s65, 0xffff
    s_mov_b32 s66, 5120000
    s_mov_b32 s67, 0x20000
    s_add_u32 s32, s32, 5242880
    s_addc_u32 s33, s33, 0
    s_and_b32 s33, s33, 0xffff
    s_mov_b32 s34, 3031040
    s_mov_b32 s35, 0x20000
    s_mov_b32 s60, s18
    s_and_b32 s61, s19, 0xffff
    s_mov_b32 s62, 256
    s_mov_b32 s63, 0x20000
    s_mov_b32 s40, s14
    s_and_b32 s41, s15, 0xffff
    s_mov_b32 s42, 262144
    s_mov_b32 s43, 0x20000
    v_mov_b32 v96, 0
    v_mov_b32 v97, 0
    v_mov_b32 v98, 0
    v_mov_b32 v99, 0
    v_add_u32 v109, 110592, v3
    s_cmp_lg_u32 s44, 1
    s_cbranch_scc1 kf_nocz
    ds_write_b128 v109, v[96:99]
    v_mov_b32 v109, 163784
    ds_write_b64 v109, v[96:97]
kf_nocz:
    v_lshrrev_b32 v108, 5, v1
    v_and_b32 v109, 3, v1
    v_lshlrev_b32 v108, 1, v108
    v_xor_b32 v108, v108, v109
    v_lshrrev_b32 v109, 2, v1
    v_lshlrev_b32 v109, 9, v109
    v_lshl_add_u32 v108, v108, 4, v109
    s_lshl_b32 s55, s44, 6
    v_add_u32 v100, s55, v108
    v_add_u32 v101, 7168, v100
    v_add_u32 v102, 14336, v100
    v_add_u32 v103, 21504, v100
    s_mul_i32 s53, s44, 12288
    v_and_b32 v108, 15, v1
    v_lshrrev_b32 v109, 4, v1
    v_xor_b32 v110, v109, v108
    v_lshlrev_b32 v110, 4, v110
    v_lshl_add_u32 v108, v108, 9, v110
    v_add_u32 v104, 126208, v108
    v_xor_b32 v110, 64, v108
    v_add_u32 v105, 126208, v110
    v_xor_b32 v110, 128, v108
    v_add_u32 v106, 126208, v110
    v_xor_b32 v110, 192, v108
    v_add_u32 v107, 126208, v110
    v_bfe_u32 v108, v1, 2, 2
    v_lshl_add_u32 v108, v109, 3, v108
    v_and_b32 v110, 1, v109
    v_lshlrev_b32 v110, 5, v110
    v_and_b32 v111, 3, v1
    v_lshl_add_u32 v110, v111, 3, v110
    v_lshl_add_u32 v110, v108, 6, v110
    v_add_u32 v90, s53, v110
    v_xor_b32 v91, 32, v90
    v_mov_b32 v111, 1
    v_lshlrev_b32 v108, 4, v0
    v_add_u32 v108, 146688, v108
    v_mov_b32 v109, 0xa0a0a0a0
    ds_write_b128 v108, v[96:99]
    v_cmp_gt_u32 vcc, 400, v0
    s_and_saveexec_b64 s[74:75], vcc
    ds_write_b128 v108, v[96:99] offset:8192
    s_mov_b64 exec, -1
    v_cmp_gt_u32 vcc, 140, v0
    s_nop 0
    s_nop 0
    v_cndmask_b32 v128, v109, -1, vcc
    v_cmp_gt_u32 vcc, 156, v0
    v_mov_b32 v129, v128
    v_mov_b32 v130, v128
    v_mov_b32 v131, v128
    s_and_saveexec_b64 s[74:75], vcc
    ds_write_b128 v108, v[128:131] offset:14592
    s_mov_b64 exec, -1
    s_mov_b32 s51, 98304
    v_lshrrev_b32 v110, 5, v1
    v_and_b32 v118, 31, v1
    v_bfe_u32 v108, v118, 2, 1
    v_cmp_eq_u32 s[96:97], v108, v110
    v_bfe_u32 v108, v118, 1, 3
    v_xor_b32 v108, v108, v110
    v_lshlrev_b32 v108, 4, v108
    v_lshl_add_u32 v108, v118, 7, v108
    v_add_u32 v14, s53, v108
    v_xor_b32 v15, 32, v14
    v_xor_b32 v16, 64, v14
    v_xor_b32 v17, 96, v14
    v_and_b32 v108, 7, v1
    v_lshrrev_b32 v109, 4, v1
    v_xor_b32 v108, v108, v109
    s_lshl_b32 s55, s46, 7
    v_lshl_add_u32 v108, v108, 4, s55
    v_xor_b32 v25, 64, v108
    v_add_u32 v19, 3072, v108
    v_add_u32 v21, 2048, v25
    v_add_u32 v23, 1024, v108
    v_bfe_u32 v108, v1, 4, 1
    v_and_b32 v109, 3, v1
    v_lshlrev_b32 v109, 3, v109
    v_lshl_add_u32 v108, v108, 5, v109
    s_add_u32 s55, s55, 98304
    v_add_u32 v7, s55, v108
    v_mov_b32 v108, 1536
    v_cndmask_b32 v8, 0, v108, s[96:97]
    s_mov_b32 s58, 0x30800000
    s_mov_b32 s59, 0x30800000
    v_bfe_u32 v108, v1, 5, 1
    v_bfe_u32 v109, v1, 3, 1
    v_bfe_u32 v110, v1, 4, 1
    v_lshlrev_b32 v4, 5, v108
    v_lshl_add_u32 v4, v109, 3, v4
    v_lshl_add_u32 v4, v110, 1, v4
    v_bfe_u32 v118, v1, 2, 2
    v_lshl_add_u32 v6, v108, 2, v118
    v_and_b32 v118, 1, v118
    v_lshl_add_u32 v5, v118, 1, v110
    v_and_b32 v108, 1, v1
    v_lshl_add_u32 v5, v5, 1, v108
    v_lshl_add_u32 v5, v5, 1, v109
    v_bfe_u32 v108, v1, 1, 1
    v_lshl_add_u32 v5, v5, 1, v108
    v_lshlrev_b32 v5, 4, v5
    v_and_b32 v108, 15, v1
    v_lshrrev_b32 v109, 4, v1
    v_lshlrev_b32 v109, 4, v109
    s_lshl_b32 s56, s44, 6
    v_add_u32 v109, s56, v109
    v_lshl_add_u32 v115, v108, 9, v109
    v_mul_u32_u24 v108, 592, v108
    v_add3_u32 v253, v108, v109, s51
    v_bfe_u32 v108, v1, 3, 2
    v_and_b32 v109, 3, v1
    v_lshl_add_u32 v108, v108, 2, v109
    v_bfe_u32 v109, v1, 2, 1
    v_lshl_add_u32 v108, v109, 4, v108
    v_lshlrev_b32 v108, 1, v108
    s_lshl_b32 s55, s46, 7
    s_add_u32 s55, s55, 122880
    v_add_u32 v117, s55, v108
    v_lshrrev_b32 v108, 1, v0
    v_mul_u32_u24 v2, 8704, v108
    s_cmp_lg_u32 s44, 1
    s_cbranch_scc1 kf_nohist
    s_movk_i32 s55, 625
    s_mov_b32 exec_hi, 0x7fffffff
    s_waitcnt vmcnt(12)
    v_mul_u32_u24 v76, 429497, v26
    v_lshrrev_b32 v76, 24, v76
    v_mad_u32_u24 v108, v76, s55, 15
    v_lshlrev_b32 v76, 2, v76
    v_add_u32 v76, 110592, v76
    ds_add_rtn_u32 v66, v76, v111
    v_lshrrev_b32 v108, 4, v108
    v_sub_u32 v26, v26, v108
    v_mul_u32_u24 v77, 429497, v27
    v_lshrrev_b32 v77, 24, v77
    v_mad_u32_u24 v108, v77, s55, 15
    v_lshlrev_b32 v77, 2, v77
    v_add_u32 v77, 110592, v77
    ds_add_rtn_u32 v67, v77, v111
    v_lshrrev_b32 v108, 4, v108
    v_sub_u32 v27, v27, v108
    v_mul_u32_u24 v78, 429497, v28
    v_lshrrev_b32 v78, 24, v78
    v_mad_u32_u24 v108, v78, s55, 15
    v_lshlrev_b32 v78, 2, v78
    v_add_u32 v78, 110592, v78
    ds_add_rtn_u32 v68, v78, v111
    v_lshrrev_b32 v108, 4, v108
    v_sub_u32 v28, v28, v108
    v_mul_u32_u24 v79, 429497, v29
    v_lshrrev_b32 v79, 24, v79
    v_mad_u32_u24 v108, v79, s55, 15
    v_lshlrev_b32 v79, 2, v79
    v_add_u32 v79, 110592, v79
    ds_add_rtn_u32 v69, v79, v111
    v_lshrrev_b32 v108, 4, v108
    v_sub_u32 v29, v29, v108
    v_mul_u32_u24 v80, 429497, v30
    v_lshrrev_b32 v80, 24, v80
    v_mad_u32_u24 v108, v80, s55, 15
    v_lshlrev_b32 v80, 2, v80
    v_add_u32 v80, 110592, v80
    ds_add_rtn_u32 v70, v80, v111
    v_lshrrev_b32 v108, 4, v108
    v_sub_u32 v30, v30, v108
    v_mul_u32_u24 v81, 429497, v31
    v_lshrrev_b32 v81, 24, v81
    v_mad_u32_u24 v108, v81, s55, 15
    v_lshlrev_b32 v81, 2, v81
    v_add_u32 v81, 110592, v81
    s_mov_b32 exec_hi, 0x3fffffff
    ds_add_rtn_u32 v71, v81, v111
    v_lshrrev_b32 v108, 4, v108
    v_sub_u32 v31, v31, v108
    v_mul_u32_u24 v82, 429497, v32
    v_lshrrev_b32 v82, 24, v82
    v_mad_u32_u24 v108, v82, s55, 15
    v_lshlrev_b32 v82, 2, v82
    v_add_u32 v82, 110592, v82
    ds_add_rtn_u32 v72, v82, v111
    v_lshrrev_b32 v108, 4, v108
    v_sub_u32 v32, v32, v108
    v_mul_u32_u24 v83, 429497, v33
    v_lshrrev_b32 v83, 24, v83
    v_mad_u32_u24 v108, v83, s55, 15
    v_lshlrev_b32 v83, 2, v83
    v_add_u32 v83, 110592, v83
    ds_add_rtn_u32 v73, v83, v111
    v_lshrrev_b32 v108, 4, v108
    v_sub_u32 v33, v33, v108
    v_mul_u32_u24 v84, 429497, v34
    v_lshrrev_b32 v84, 24, v84
    v_mad_u32_u24 v108, v84, s55, 15
    v_lshlrev_b32 v84, 2, v84
    v_add_u32 v84, 110592, v84
    ds_add_rtn_u32 v74, v84, v111
    v_lshrrev_b32 v108, 4, v108
    v_sub_u32 v34, v34, v108
    v_mul_u32_u24 v85, 429497, v35
    v_lshrrev_b32 v85, 24, v85
    v_mad_u32_u24 v108, v85, s55, 15
    v_lshlrev_b32 v85, 2, v85
    v_add_u32 v85, 110592, v85
    ds_add_rtn_u32 v75, v85, v111
    v_lshrrev_b32 v108, 4, v108
    v_sub_u32 v35, v35, v108
    s_mov_b32 exec_hi, -1
    v_add_u32 v108, 110592, v3
    ds_read_b128 v[92:95], v108
    s_waitcnt vmcnt(9)
    v_lshl_or_b32 v36, v26, 16, v36
    v_lshl_or_b32 v37, v27, 16, v37
    v_lshl_or_b32 v38, v28, 16, v38
    v_lshl_or_b32 v39, v29, 16, v39
    v_lshl_or_b32 v40, v30, 16, v40
    v_lshl_or_b32 v41, v31, 16, v41
    v_lshl_or_b32 v42, v32, 16, v42
    v_lshl_or_b32 v43, v33, 16, v43
    v_lshl_or_b32 v44, v34, 16, v44
    v_lshl_or_b32 v45, v35, 16, v45
    s_waitcnt lgkmcnt(0)
    v_add_u32 v97, v92, v93
    v_add_u32 v98, v97, v94
    v_add_u32 v109, v98, v95
    v_mov_b32 v110, v109
    s_nop 1
    v_add_u32_dpp v110, v110, v110 row_shr:1 row_mask:0xf bank_mask:0xf bound_ctrl:0
    s_nop 1
    v_add_u32_dpp v110, v110, v110 row_shr:2 row_mask:0xf bank_mask:0xf bound_ctrl:0
    s_nop 1
    v_add_u32_dpp v110, v110, v110 row_shr:4 row_mask:0xf bank_mask:0xf bound_ctrl:0
    s_nop 1
    v_add_u32_dpp v110, v110, v110 row_shr:8 row_mask:0xf bank_mask:0xf bound_ctrl:0
    s_nop 1
    v_add_u32_dpp v110, v110, v110 row_bcast:15 row_mask:0xa bank_mask:0xf
    s_nop 1
    v_add_u32_dpp v110, v110, v110 row_bcast:31 row_mask:0xc bank_mask:0xf
    s_nop 1
    v_sub_u32 v96, v110, v109
    v_add_u32 v99, v98, v96
    v_add_u32 v98, v97, v96
    v_add_u32 v97, v92, v96
    ds_write_b128 v108, v[96:99] offset:1024
    ds_read_b32 v26, v76 offset:1024
    ds_read_b32 v27, v77 offset:1024
    ds_read_b32 v28, v78 offset:1024
    ds_read_b32 v29, v79 offset:1024
    ds_read_b32 v30, v80 offset:1024
    ds_read_b32 v31, v81 offset:1024
    ds_read_b32 v32, v82 offset:1024
    ds_read_b32 v33, v83 offset:1024
    ds_read_b32 v34, v84 offset:1024
    ds_read_b32 v35, v85 offset:1024
    v_lshl_or_b32 v96, v92, 16, v96
    v_lshl_or_b32 v97, v93, 16, v97
    v_lshl_or_b32 v98, v94, 16, v98
    v_lshl_or_b32 v99, v95, 16, v99
    v_subrev_u32 v108, 12288, v108
    s_mov_b32 s55, 99328
    s_mov_b32 exec_hi, 0x7fffffff
    s_waitcnt vmcnt(4)
    s_waitcnt lgkmcnt(9)
    v_add_u32 v26, v26, v66
    v_mad_u32_u24 v26, v26, 12, s55
    ds_write2_b32 v26, v46, v47 offset1:1
    ds_write_b32 v26, v36 offset:8
    s_waitcnt lgkmcnt(9)
    v_add_u32 v27, v27, v67
    v_mad_u32_u24 v27, v27, 12, s55
    ds_write2_b32 v27, v48, v49 offset1:1
    ds_write_b32 v27, v37 offset:8
    s_waitcnt lgkmcnt(9)
    v_add_u32 v28, v28, v68
    v_mad_u32_u24 v28, v28, 12, s55
    ds_write2_b32 v28, v50, v51 offset1:1
    ds_write_b32 v28, v38 offset:8
    s_waitcnt lgkmcnt(9)
    v_add_u32 v29, v29, v69
    v_mad_u32_u24 v29, v29, 12, s55
    ds_write2_b32 v29, v52, v53 offset1:1
    ds_write_b32 v29, v39 offset:8
    s_waitcnt lgkmcnt(9)
    v_add_u32 v30, v30, v70
    v_mad_u32_u24 v30, v30, 12, s55
    ds_write2_b32 v30, v54, v55 offset1:1
    ds_write_b32 v30, v40 offset:8
    s_mov_b32 exec_hi, 0x3fffffff
    s_waitcnt lgkmcnt(9)
    v_add_u32 v31, v31, v71
    v_mad_u32_u24 v31, v31, 12, s55
    ds_write2_b32 v31, v56, v57 offset1:1
    ds_write_b32 v31, v41 offset:8
    s_waitcnt lgkmcnt(9)
    v_add_u32 v32, v32, v72
    v_mad_u32_u24 v32, v32, 12, s55
    ds_write2_b32 v32, v58, v59 offset1:1
    ds_write_b32 v32, v42 offset:8
    s_waitcnt lgkmcnt(9)
    v_add_u32 v33, v33, v73
    v_mad_u32_u24 v33, v33, 12, s55
    ds_write2_b32 v33, v60, v61 offset1:1
    ds_write_b32 v33, v43 offset:8
    s_waitcnt lgkmcnt(9)
    v_add_u32 v34, v34, v74
    v_mad_u32_u24 v34, v34, 12, s55
    ds_write2_b32 v34, v62, v63 offset1:1
    ds_write_b32 v34, v44 offset:8
    s_waitcnt lgkmcnt(9)
    v_add_u32 v35, v35, v75
    v_mad_u32_u24 v35, v35, 12, s55
    ds_write2_b32 v35, v64, v65 offset1:1
    ds_write_b32 v35, v45 offset:8
    s_mov_b32 exec_hi, -1
    ds_write_b128 v108, v[96:99]
    s_setprio 0
kf_nohist:
    s_add_u32 m0, s53, 0
    s_mov_b32 s57, 0
    buffer_load_dwordx4 v100, s[68:71], s57 offen offset:0 lds
    buffer_load_dwordx4 v101, s[68:71], s57 offen offset:1024 lds
    buffer_load_dwordx4 v102, s[68:71], s57 offen offset:2048 lds
    buffer_load_dwordx4 v103, s[68:71], s57 offen offset:3072 lds
    s_add_u32 m0, s53, 4096
    s_mov_b32 s57, 32768
    buffer_load_dwordx4 v100, s[68:71], s57 offen offset:0 lds
    buffer_load_dwordx4 v101, s[68:71], s57 offen offset:1024 lds
    buffer_load_dwordx4 v102, s[68:71], s57 offen offset:2048 lds
    buffer_load_dwordx4 v103, s[68:71], s57 offen offset:3072 lds
    s_waitcnt vmcnt(8) lgkmcnt(0)
    s_barrier
    s_or_b32 s55, s2, s44
    s_cbranch_scc1 kf_noset
    v_mov_b32 v108, 1
    v_mov_b32 v109, 0
    s_mov_b64 exec, 1
    buffer_store_dword v108, v109, s[60:63], 0 offen sc1
    s_mov_b64 exec, -1
kf_noset:
    s_setprio 2
    v_lshlrev_b32 v111, 4, v0
    v_add_u32 v108, 98304, v111
    ds_read_b128 v[92:95], v108
    ds_read_b128 v[96:99], v108 offset:8192
    ds_read_b128 v[156:159], v104 offset:0
    ds_read_b128 v[160:163], v104 offset:8192
    ds_read_b128 v[164:167], v104 offset:16384
    ds_read_b128 v[168:171], v105 offset:0
    ds_read_b128 v[172:175], v105 offset:8192
    ds_read_b128 v[176:179], v105 offset:16384
    ds_read_b128 v[180:183], v106 offset:0
    ds_read_b128 v[184:187], v106 offset:8192
    ds_read_b128 v[188:191], v106 offset:16384
    ds_read_b128 v[192:195], v107 offset:0
    ds_read_b128 v[196:199], v107 offset:8192
    ds_read_b128 v[200:203], v107 offset:16384
    s_add_u32 m0, s53, 8192
    s_mov_b32 s57, 65536
    buffer_load_dwordx4 v100, s[68:71], s57 offen offset:0 lds
    buffer_load_dwordx4 v101, s[68:71], s57 offen offset:1024 lds
    buffer_load_dwordx4 v102, s[68:71], s57 offen offset:2048 lds
    buffer_load_dwordx4 v103, s[68:71], s57 offen offset:3072 lds
    s_waitcnt lgkmcnt(0)
    s_mul_i32 s51, s2, 8704
    s_add_u32 s52, s51, 8192
    s_cmp_lg_u32 s44, 0
    s_cbranch_scc1 kf_nost2
    s_mov_b32 exec_hi, 0
    buffer_store_dwordx4 v[96:99], v111, s[32:35], s52 offen sc1
    s_mov_b32 exec_hi, -1
kf_nost2:
    buffer_store_dwordx4 v[92:95], v111, s[32:35], s51 offen sc1
    s_cmp_lg_u32 s44, 0
    s_cbranch_scc1 kf_nodb
    v_mov_b32 v252, 0
    buffer_load_dword v252, v252, s[60:63], 0 offen sc1
kf_nodb:
    s_cmp_lg_u32 s44, 7
    s_cbranch_scc1 kf_norl
    s_cmp_ge_u32 s2, 128
    s_cbranch_scc1 kf_norl
    v_lshrrev_b32 v108, 4, v1
    v_lshlrev_b32 v108, 11, v108
    v_bfe_u32 v109, v1, 2, 2
    v_lshl_add_u32 v108, v109, 4, v108
    v_and_b32 v109, 3, v1
    v_lshl_add_u32 v108, v109, 1, v108
    s_bfe_u32 s55, s2, 0x30001
    s_lshl_b32 s56, s55, 14
    s_add_u32 s56, s56, 131072
    s_bfe_u32 s55, s2, 0x30004
    s_lshl_b32 s55, s55, 6
    s_add_u32 s56, s56, s55
    s_and_b32 s55, s2, 1
    s_lshl_b32 s55, s55, 3
    s_add_u32 s56, s56, s55
    s_add_u32 s55, s56, 8192
    buffer_load_ushort v50, v108, s[40:43], s56 offen offset:0
    buffer_load_ushort v51, v108, s[40:43], s56 offen offset:512
    buffer_load_ushort v52, v108, s[40:43], s56 offen offset:1024
    buffer_load_ushort v53, v108, s[40:43], s56 offen offset:1536
    buffer_load_ushort v54, v108, s[40:43], s55 offen offset:0
    buffer_load_ushort v55, v108, s[40:43], s55 offen offset:512
    buffer_load_ushort v56, v108, s[40:43], s55 offen offset:1024
    buffer_load_ushort v57, v108, s[40:43], s55 offen offset:1536
kf_norl:
    ds_read_u16 v58, v117 offset:0
    ds_read_u16 v59, v117 offset:512
    ds_read_u16 v60, v117 offset:1024
    ds_read_u16 v61, v117 offset:1536
    ds_read_u16 v62, v117 offset:64
    ds_read_u16 v63, v117 offset:576
    ds_read_u16 v64, v117 offset:1088
    ds_read_u16 v65, v117 offset:1600
    s_waitcnt lgkmcnt(2)
    ds_read_b128 v[204:207], v104 offset:256
    ds_read_b128 v[208:211], v104 offset:8448
    ds_read_b128 v[212:215], v104 offset:16640
    ds_read_b128 v[216:219], v105 offset:256
    ds_read_b128 v[220:223], v105 offset:8448
    ds_read_b128 v[224:227], v105 offset:16640
    ds_read_b128 v[228:231], v106 offset:256
    ds_read_b128 v[232:235], v106 offset:8448
    ds_read_b128 v[236:239], v106 offset:16640
    ds_read_b128 v[240:243], v107 offset:256
    ds_read_b128 v[244:247], v107 offset:8448
    ds_read_b128 v[248:251], v107 offset:16640
    s_waitcnt lgkmcnt(6)
    s_waitcnt vmcnt(9)
    ds_read_b64_tr_b16 v[124:125], v90 offset:0
    ds_read_b64_tr_b16 v[126:127], v90 offset:256
    ds_read_b64_tr_b16 v[128:129], v91 offset:0
    ds_read_b64_tr_b16 v[130:131], v91 offset:256
    ds_read_b64_tr_b16 v[132:133], v90 offset:2048
    ds_read_b64_tr_b16 v[134:135], v90 offset:2304
    ds_read_b64_tr_b16 v[136:137], v91 offset:2048
    ds_read_b64_tr_b16 v[138:139], v91 offset:2304
    s_waitcnt lgkmcnt(0)
    v_mfma_f32_16x16x32_bf16 v[26:29], v[124:127], v[156:159], 0
    v_mfma_f32_16x16x32_bf16 v[30:33], v[128:131], v[156:159], 0
    s_waitcnt vmcnt(5)
    ds_read_b64_tr_b16 v[140:141], v90 offset:4096
    ds_read_b64_tr_b16 v[142:143], v90 offset:4352
    ds_read_b64_tr_b16 v[144:145], v91 offset:4096
    ds_read_b64_tr_b16 v[146:147], v91 offset:4352
    ds_read_b64_tr_b16 v[148:149], v90 offset:6144
    ds_read_b64_tr_b16 v[150:151], v90 offset:6400
    ds_read_b64_tr_b16 v[152:153], v91 offset:6144
    ds_read_b64_tr_b16 v[154:155], v91 offset:6400
    v_mfma_f32_16x16x32_bf16 v[34:37], v[124:127], v[160:163], 0
    v_mfma_f32_16x16x32_bf16 v[38:41], v[128:131], v[160:163], 0
    v_mfma_f32_16x16x32_bf16 v[42:45], v[124:127], v[164:167], 0
    v_mfma_f32_16x16x32_bf16 v[46:49], v[128:131], v[164:167], 0
    v_mfma_f32_16x16x32_bf16 v[26:29], v[132:135], v[168:171], v[26:29]
    v_mfma_f32_16x16x32_bf16 v[30:33], v[136:139], v[168:171], v[30:33]
    s_add_u32 m0, s53, 0
    s_mov_b32 s57, 98304
    buffer_load_dwordx4 v100, s[68:71], s57 offen offset:0 lds
    buffer_load_dwordx4 v101, s[68:71], s57 offen offset:1024 lds
    buffer_load_dwordx4 v102, s[68:71], s57 offen offset:2048 lds
    buffer_load_dwordx4 v103, s[68:71], s57 offen offset:3072 lds
    v_mfma_f32_16x16x32_bf16 v[34:37], v[132:135], v[172:175], v[34:37]
    v_mfma_f32_16x16x32_bf16 v[38:41], v[136:139], v[172:175], v[38:41]
    v_mfma_f32_16x16x32_bf16 v[42:45], v[132:135], v[176:179], v[42:45]
    v_mfma_f32_16x16x32_bf16 v[46:49], v[136:139], v[176:179], v[46:49]
    s_waitcnt lgkmcnt(0)
    v_mfma_f32_16x16x32_bf16 v[26:29], v[140:143], v[180:183], v[26:29]
    v_mfma_f32_16x16x32_bf16 v[30:33], v[144:147], v[180:183], v[30:33]
    s_waitcnt vmcnt(5)
    ds_read_b64_tr_b16 v[124:125], v90 offset:8192
    ds_read_b64_tr_b16 v[126:127], v90 offset:8448
    ds_read_b64_tr_b16 v[128:129], v91 offset:8192
    ds_read_b64_tr_b16 v[130:131], v91 offset:8448
    ds_read_b64_tr_b16 v[132:133], v90 offset:10240
    ds_read_b64_tr_b16 v[134:135], v90 offset:10496
    ds_read_b64_tr_b16 v[136:137], v91 offset:10240
    ds_read_b64_tr_b16 v[138:139], v91 offset:10496
    v_mfma_f32_16x16x32_bf16 v[34:37], v[140:143], v[184:187], v[34:37]
    v_mfma_f32_16x16x32_bf16 v[38:41], v[144:147], v[184:187], v[38:41]
    v_mfma_f32_16x16x32_bf16 v[42:45], v[140:143], v[188:191], v[42:45]
    v_mfma_f32_16x16x32_bf16 v[46:49], v[144:147], v[188:191], v[46:49]
    v_mfma_f32_16x16x32_bf16 v[26:29], v[148:151], v[192:195], v[26:29]
    v_mfma_f32_16x16x32_bf16 v[30:33], v[152:155], v[192:195], v[30:33]
    s_add_u32 m0, s53, 4096
    s_mov_b32 s57, 131072
    buffer_load_dwordx4 v100, s[68:71], s57 offen offset:0 lds
    buffer_load_dwordx4 v101, s[68:71], s57 offen offset:1024 lds
    buffer_load_dwordx4 v102, s[68:71], s57 offen offset:2048 lds
    buffer_load_dwordx4 v103, s[68:71], s57 offen offset:3072 lds
    v_mfma_f32_16x16x32_bf16 v[34:37], v[148:151], v[196:199], v[34:37]
    v_mfma_f32_16x16x32_bf16 v[38:41], v[152:155], v[196:199], v[38:41]
    v_mfma_f32_16x16x32_bf16 v[42:45], v[148:151], v[200:203], v[42:45]
    v_mfma_f32_16x16x32_bf16 v[46:49], v[152:155], v[200:203], v[46:49]
    s_mov_b32 s55, 0xbfb8aa3b
    v_lshlrev_b32 v58, 16, v58
    v_mul_f32 v58, s55, v58
    v_lshlrev_b32 v59, 16, v59
    v_mul_f32 v59, s55, v59
    v_lshlrev_b32 v60, 16, v60
    v_mul_f32 v60, s55, v60
    v_lshlrev_b32 v61, 16, v61
    v_mul_f32 v61, s55, v61
    v_lshlrev_b32 v62, 16, v62
    v_mul_f32 v62, s55, v62
    v_lshlrev_b32 v63, 16, v63
    v_mul_f32 v63, s55, v63
    v_lshlrev_b32 v64, 16, v64
    v_mul_f32 v64, s55, v64
    v_lshlrev_b32 v65, 16, v65
    v_mul_f32 v65, s55, v65
    v_cvt_pk_bf16_f32 v58, v58, v59
    v_cvt_pk_bf16_f32 v59, v60, v61
    v_cvt_pk_bf16_f32 v60, v62, v63
    v_cvt_pk_bf16_f32 v61, v64, v65
    s_waitcnt vmcnt(8)
    s_cmp_lg_u32 s44, 0
    s_cbranch_scc1 kf_initok
    s_mov_b32 s49, 400000
kf_initpoll:
    v_readfirstlane_b32 s55, v252
    s_cmp_lg_u32 s55, 0
    s_cbranch_scc1 kf_initok
    v_mov_b32 v252, 0
    s_sleep 2
    buffer_load_dword v252, v252, s[60:63], 0 offen sc1
    s_waitcnt vmcnt(0)
    s_sub_u32 s49, s49, 1
    s_cbranch_scc0 kf_initpoll
kf_initok:
    s_barrier
    s_cmp_lg_u32 s44, 0
    s_cbranch_scc1 kf_sigA
    v_lshlrev_b32 v86, 10, v1
    v_mov_b32 v87, 1
    s_lshl_b32 s55, s2, 2
    s_add_u32 s55, s55, 3014656
    s_mov_b64 exec, 0xff
    buffer_store_dword v87, v86, s[32:35], s55 offen sc1
    s_mov_b64 exec, -1
kf_sigA:
    s_cmp_lt_u32 s44, 4
    s_cbranch_scc1 kf_nt2
    s_and_b32 s55, s2, 0xf8
    s_lshl_b32 s55, s55, 9
    s_lshl_b32 s56, s46, 10
    s_add_u32 s55, s55, s56
    buffer_load_dwordx4 v[66:69], v3, s[40:43], s55 offen
kf_nt2:
    s_waitcnt lgkmcnt(0)
    v_mfma_f32_16x16x32_bf16 v[26:29], v[124:127], v[204:207], v[26:29]
    v_mfma_f32_16x16x32_bf16 v[30:33], v[128:131], v[204:207], v[30:33]
    s_waitcnt vmcnt(4)
    ds_read_b64_tr_b16 v[140:141], v90 offset:0
    ds_read_b64_tr_b16 v[142:143], v90 offset:256
    ds_read_b64_tr_b16 v[144:145], v91 offset:0
    ds_read_b64_tr_b16 v[146:147], v91 offset:256
    ds_read_b64_tr_b16 v[148:149], v90 offset:2048
    ds_read_b64_tr_b16 v[150:151], v90 offset:2304
    ds_read_b64_tr_b16 v[152:153], v91 offset:2048
    ds_read_b64_tr_b16 v[154:155], v91 offset:2304
    v_mfma_f32_16x16x32_bf16 v[34:37], v[124:127], v[208:211], v[34:37]
    v_mfma_f32_16x16x32_bf16 v[38:41], v[128:131], v[208:211], v[38:41]
    v_mfma_f32_16x16x32_bf16 v[42:45], v[124:127], v[212:215], v[42:45]
    v_mfma_f32_16x16x32_bf16 v[46:49], v[128:131], v[212:215], v[46:49]
    v_mfma_f32_16x16x32_bf16 v[26:29], v[132:135], v[216:219], v[26:29]
    v_mfma_f32_16x16x32_bf16 v[30:33], v[136:139], v[216:219], v[30:33]
    s_add_u32 m0, s53, 8192
    s_mov_b32 s57, 163840
    buffer_load_dwordx4 v100, s[68:71], s57 offen offset:0 lds
    buffer_load_dwordx4 v101, s[68:71], s57 offen offset:1024 lds
    buffer_load_dwordx4 v102, s[68:71], s57 offen offset:2048 lds
    buffer_load_dwordx4 v103, s[68:71], s57 offen offset:3072 lds
    v_mfma_f32_16x16x32_bf16 v[34:37], v[132:135], v[220:223], v[34:37]
    v_mfma_f32_16x16x32_bf16 v[38:41], v[136:139], v[220:223], v[38:41]
    v_mfma_f32_16x16x32_bf16 v[42:45], v[132:135], v[224:227], v[42:45]
    v_mfma_f32_16x16x32_bf16 v[46:49], v[136:139], v[224:227], v[46:49]
    s_waitcnt lgkmcnt(0)
    v_mfma_f32_16x16x32_bf16 v[26:29], v[140:143], v[228:231], v[26:29]
    v_mfma_f32_16x16x32_bf16 v[30:33], v[144:147], v[228:231], v[30:33]
    s_waitcnt vmcnt(4)
    ds_read_b64_tr_b16 v[124:125], v90 offset:4096
    ds_read_b64_tr_b16 v[126:127], v90 offset:4352
    ds_read_b64_tr_b16 v[128:129], v91 offset:4096
    ds_read_b64_tr_b16 v[130:131], v91 offset:4352
    ds_read_b64_tr_b16 v[132:133], v90 offset:6144
    ds_read_b64_tr_b16 v[134:135], v90 offset:6400
    ds_read_b64_tr_b16 v[136:137], v91 offset:6144
    ds_read_b64_tr_b16 v[138:139], v91 offset:6400
    v_mfma_f32_16x16x32_bf16 v[34:37], v[140:143], v[232:235], v[34:37]
    v_mfma_f32_16x16x32_bf16 v[38:41], v[144:147], v[232:235], v[38:41]
    v_mfma_f32_16x16x32_bf16 v[42:45], v[140:143], v[236:239], v[42:45]
    v_mfma_f32_16x16x32_bf16 v[46:49], v[144:147], v[236:239], v[46:49]
    v_mfma_f32_16x16x32_bf16 v[26:29], v[148:151], v[240:243], v[26:29]
    v_mfma_f32_16x16x32_bf16 v[30:33], v[152:155], v[240:243], v[30:33]
    v_mfma_f32_16x16x32_bf16 v[34:37], v[148:151], v[244:247], v[34:37]
    v_mfma_f32_16x16x32_bf16 v[38:41], v[152:155], v[244:247], v[38:41]
    v_mfma_f32_16x16x32_bf16 v[42:45], v[148:151], v[248:251], v[42:45]
    v_mfma_f32_16x16x32_bf16 v[46:49], v[152:155], v[248:251], v[46:49]
    s_cmp_lg_u32 s44, 7
    s_cbranch_scc1 kf_norl2
    s_cmp_ge_u32 s2, 128
    s_cbranch_scc1 kf_norl2
    v_lshl_or_b32 v50, v51, 16, v50
    v_lshl_or_b32 v51, v53, 16, v52
    v_lshl_or_b32 v52, v55, 16, v54
    v_lshl_or_b32 v53, v57, 16, v56
    s_and_b32 s56, s2, 15
    s_cmp_lt_u32 s56, 12
    s_cbranch_scc1 kf_rlring
    s_lshl_b32 s55, s2, 10
    s_add_u32 s55, s55, 2883584
    buffer_store_dwordx4 v[50:53], v3, s[32:35], s55 offen sc1
    s_branch kf_norl2
kf_rlring:
    s_add_u32 s20, s64, 5120000
    s_addc_u32 s21, s65, 0
    s_mov_b32 s22, 98304
    s_mov_b32 s23, 0x20000
    s_bfe_u32 s55, s2, 0x10006
    s_mul_i32 s55, s55, 96
    s_lshr_b32 s57, s56, 2
    s_lshl_b32 s57, s57, 5
    s_add_u32 s55, s55, s57
    s_and_b32 s57, s56, 2
    s_lshl_b32 s57, s57, 2
    s_add_u32 s55, s55, s57
    s_and_b32 s56, s56, 1
    s_lshl_b32 s57, s56, 1
    s_add_u32 s55, s55, s57
    s_lshl_b32 s55, s55, 9
    s_bfe_u32 s57, s2, 0x20004
    s_lshl_b32 s57, s57, 7
    s_add_u32 s55, s55, s57
    s_lshl_b32 s56, s56, 6
    v_and_b32 v108, 7, v1
    v_lshrrev_b32 v109, 4, v1
    v_xor_b32 v108, v108, v109
    v_lshlrev_b32 v108, 4, v108
    v_xor_b32 v108, s56, v108
    v_lshl_add_u32 v108, v4, 8, v108
    buffer_store_dwordx4 v[50:53], v108, s[20:23], s55 offen sc1
kf_norl2:
    s_mov_b32 s74, 0xbfb8aa3b
    s_mov_b32 s75, 0xbfb8aa3b
    s_lshl_b32 s55, s98, 9
    s_nop 4
    v_pk_mul_f32 v[26:27], v[26:27], s[74:75]
    v_pk_mul_f32 v[28:29], v[28:29], s[74:75]
    v_pk_mul_f32 v[30:31], v[30:31], s[74:75]
    v_pk_mul_f32 v[32:33], v[32:33], s[74:75]
    v_cvt_pk_bf16_f32 v26, v26, v27
    v_cvt_pk_bf16_f32 v27, v28, v29
    v_cvt_pk_bf16_f32 v28, v30, v31
    v_cvt_pk_bf16_f32 v29, v32, v33
    buffer_store_dwordx4 v[26:29], v115, s[64:67], s55 offen sc1
    s_add_u32 s55, s55, 8192
    v_pk_mul_f32 v[34:35], v[34:35], s[74:75]
    v_pk_mul_f32 v[36:37], v[36:37], s[74:75]
    v_pk_mul_f32 v[38:39], v[38:39], s[74:75]
    v_pk_mul_f32 v[40:41], v[40:41], s[74:75]
    v_cvt_pk_bf16_f32 v34, v34, v35
    v_cvt_pk_bf16_f32 v35, v36, v37
    v_cvt_pk_bf16_f32 v36, v38, v39
    v_cvt_pk_bf16_f32 v37, v40, v41
    buffer_store_dwordx4 v[34:37], v115, s[64:67], s55 offen sc1
    s_add_u32 s55, s55, 8192
    v_pk_mul_f32 v[42:43], v[42:43], s[74:75]
    v_pk_mul_f32 v[44:45], v[44:45], s[74:75]
    v_pk_mul_f32 v[46:47], v[46:47], s[74:75]
    v_pk_mul_f32 v[48:49], v[48:49], s[74:75]
    v_cvt_pk_bf16_f32 v42, v42, v43
    v_cvt_pk_bf16_f32 v43, v44, v45
    v_cvt_pk_bf16_f32 v44, v46, v47
    v_cvt_pk_bf16_f32 v45, v48, v49
    s_mov_b32 exec_lo, 0x00ff00ff
    s_mov_b32 exec_hi, 0x00ff00ff
    buffer_store_dwordx4 v[42:45], v115, s[64:67], s55 offen sc1
    s_mov_b64 exec, -1
    s_setprio 0
    s_add_u32 m0, s53, 0
    s_mov_b32 s57, 196608
    buffer_load_dwordx4 v100, s[68:71], s57 offen offset:0 lds
    buffer_load_dwordx4 v101, s[68:71], s57 offen offset:1024 lds
    buffer_load_dwordx4 v102, s[68:71], s57 offen offset:2048 lds
    buffer_load_dwordx4 v103, s[68:71], s57 offen offset:3072 lds
    s_mov_b32 s24, s16
    s_and_b32 s25, s17, 0xffff
    s_mov_b32 s26, 5120000
    s_mov_b32 s27, 0x20000
    s_waitcnt lgkmcnt(0)
    v_mfma_f32_16x16x32_bf16 v[26:29], v[124:127], v[156:159], 0
    v_mfma_f32_16x16x32_bf16 v[30:33], v[128:131], v[156:159], 0
    s_waitcnt vmcnt(7)
    ds_read_b64_tr_b16 v[140:141], v90 offset:8192
    ds_read_b64_tr_b16 v[142:143], v90 offset:8448
    ds_read_b64_tr_b16 v[144:145], v91 offset:8192
    ds_read_b64_tr_b16 v[146:147], v91 offset:8448
    ds_read_b64_tr_b16 v[148:149], v90 offset:10240
    ds_read_b64_tr_b16 v[150:151], v90 offset:10496
    ds_read_b64_tr_b16 v[152:153], v91 offset:10240
    ds_read_b64_tr_b16 v[154:155], v91 offset:10496
    v_mfma_f32_16x16x32_bf16 v[34:37], v[124:127], v[160:163], 0
    v_mfma_f32_16x16x32_bf16 v[38:41], v[128:131], v[160:163], 0
    v_mfma_f32_16x16x32_bf16 v[42:45], v[124:127], v[164:167], 0
    v_mfma_f32_16x16x32_bf16 v[46:49], v[128:131], v[164:167], 0
    v_mfma_f32_16x16x32_bf16 v[26:29], v[132:135], v[168:171], v[26:29]
    v_mfma_f32_16x16x32_bf16 v[30:33], v[136:139], v[168:171], v[30:33]
    s_add_u32 m0, s53, 4096
    s_mov_b32 s57, 229376
    buffer_load_dwordx4 v100, s[68:71], s57 offen offset:0 lds
    buffer_load_dwordx4 v101, s[68:71], s57 offen offset:1024 lds
    buffer_load_dwordx4 v102, s[68:71], s57 offen offset:2048 lds
    buffer_load_dwordx4 v103, s[68:71], s57 offen offset:3072 lds
    v_mfma_f32_16x16x32_bf16 v[34:37], v[132:135], v[172:175], v[34:37]
    v_mfma_f32_16x16x32_bf16 v[38:41], v[136:139], v[172:175], v[38:41]
    v_mfma_f32_16x16x32_bf16 v[42:45], v[132:135], v[176:179], v[42:45]
    v_mfma_f32_16x16x32_bf16 v[46:49], v[136:139], v[176:179], v[46:49]
    s_waitcnt lgkmcnt(0)
    v_mfma_f32_16x16x32_bf16 v[26:29], v[140:143], v[180:183], v[26:29]
    v_mfma_f32_16x16x32_bf16 v[30:33], v[144:147], v[180:183], v[30:33]
    v_mfma_f32_16x16x32_bf16 v[34:37], v[140:143], v[184:187], v[34:37]
    v_mfma_f32_16x16x32_bf16 v[38:41], v[144:147], v[184:187], v[38:41]
    v_mfma_f32_16x16x32_bf16 v[42:45], v[140:143], v[188:191], v[42:45]
    v_mfma_f32_16x16x32_bf16 v[46:49], v[144:147], v[188:191], v[46:49]
    v_mfma_f32_16x16x32_bf16 v[26:29], v[148:151], v[192:195], v[26:29]
    v_mfma_f32_16x16x32_bf16 v[30:33], v[152:155], v[192:195], v[30:33]
    v_mfma_f32_16x16x32_bf16 v[34:37], v[148:151], v[196:199], v[34:37]
    v_mfma_f32_16x16x32_bf16 v[38:41], v[152:155], v[196:199], v[38:41]
    v_mfma_f32_16x16x32_bf16 v[42:45], v[148:151], v[200:203], v[42:45]
    v_mfma_f32_16x16x32_bf16 v[46:49], v[152:155], v[200:203], v[46:49]
    s_cmp_lg_u32 s44, 0
    s_cbranch_scc1 kf_pollA_ok
    s_and_b32 s55, s2, 7
    s_lshl_b32 s55, s55, 10
    s_add_u32 s55, s55, 3014656
    s_mov_b32 s49, 400000
kf_pollA:
    buffer_load_dwordx4 v[92:95], v3, s[32:35], s55 offen sc1
    s_waitcnt vmcnt(0)
    v_and_b32 v92, v92, v93
    v_and_b32 v94, v94, v95
    v_and_b32 v92, v92, v94
    v_cmp_eq_u32 vcc, 1, v92
    s_cmp_eq_u64 vcc, -1
    s_cbranch_scc1 kf_pollA_ok
    s_sleep 1
    s_sub_u32 s49, s49, 1
    s_cbranch_scc0 kf_pollA
kf_pollA_ok:
    s_waitcnt vmcnt(0)
    s_barrier
    s_lshl_b32 s55, s0, 2
    buffer_load_dword v252, v2, s[32:35], s55 offen
    s_cmp_lg_u32 s44, 0
    s_cbranch_scc1 kf_sigB
    v_lshlrev_b32 v86, 10, v1
    v_mov_b32 v87, 1
    s_lshl_b32 s55, s2, 2
    s_add_u32 s55, s55, 3022848
    s_mov_b64 exec, 0xff
    buffer_store_dword v87, v86, s[32:35], s55 offen sc1
    s_mov_b64 exec, -1
kf_sigB:
    ds_read_b64_tr_b16 v[124:125], v90 offset:0
    ds_read_b64_tr_b16 v[126:127], v90 offset:256
    ds_read_b64_tr_b16 v[128:129], v91 offset:0
    ds_read_b64_tr_b16 v[130:131], v91 offset:256
    ds_read_b64_tr_b16 v[132:133], v90 offset:2048
    ds_read_b64_tr_b16 v[134:135], v90 offset:2304
    ds_read_b64_tr_b16 v[136:137], v91 offset:2048
    ds_read_b64_tr_b16 v[138:139], v91 offset:2304
    s_waitcnt lgkmcnt(0)
    v_mfma_f32_16x16x32_bf16 v[26:29], v[124:127], v[204:207], v[26:29]
    v_mfma_f32_16x16x32_bf16 v[30:33], v[128:131], v[204:207], v[30:33]
    ds_read_b64_tr_b16 v[140:141], v90 offset:4096
    ds_read_b64_tr_b16 v[142:143], v90 offset:4352
    ds_read_b64_tr_b16 v[144:145], v91 offset:4096
    ds_read_b64_tr_b16 v[146:147], v91 offset:4352
    ds_read_b64_tr_b16 v[148:149], v90 offset:6144
    ds_read_b64_tr_b16 v[150:151], v90 offset:6400
    ds_read_b64_tr_b16 v[152:153], v91 offset:6144
    ds_read_b64_tr_b16 v[154:155], v91 offset:6400
    v_mfma_f32_16x16x32_bf16 v[34:37], v[124:127], v[208:211], v[34:37]
    v_mfma_f32_16x16x32_bf16 v[38:41], v[128:131], v[208:211], v[38:41]
    v_mfma_f32_16x16x32_bf16 v[42:45], v[124:127], v[212:215], v[42:45]
    v_mfma_f32_16x16x32_bf16 v[46:49], v[128:131], v[212:215], v[46:49]
    v_mfma_f32_16x16x32_bf16 v[26:29], v[132:135], v[216:219], v[26:29]
    v_mfma_f32_16x16x32_bf16 v[30:33], v[136:139], v[216:219], v[30:33]
    v_mfma_f32_16x16x32_bf16 v[34:37], v[132:135], v[220:223], v[34:37]
    v_mfma_f32_16x16x32_bf16 v[38:41], v[136:139], v[220:223], v[38:41]
    v_mfma_f32_16x16x32_bf16 v[42:45], v[132:135], v[224:227], v[42:45]
    v_mfma_f32_16x16x32_bf16 v[46:49], v[136:139], v[224:227], v[46:49]
    s_waitcnt lgkmcnt(0)
    v_mfma_f32_16x16x32_bf16 v[26:29], v[140:143], v[228:231], v[26:29]
    v_mfma_f32_16x16x32_bf16 v[30:33], v[144:147], v[228:231], v[30:33]
    v_mfma_f32_16x16x32_bf16 v[34:37], v[140:143], v[232:235], v[34:37]
    v_mfma_f32_16x16x32_bf16 v[38:41], v[144:147], v[232:235], v[38:41]
    v_mfma_f32_16x16x32_bf16 v[42:45], v[140:143], v[236:239], v[42:45]
    v_mfma_f32_16x16x32_bf16 v[46:49], v[144:147], v[236:239], v[46:49]
    v_mfma_f32_16x16x32_bf16 v[26:29], v[148:151], v[240:243], v[26:29]
    v_mfma_f32_16x16x32_bf16 v[30:33], v[152:155], v[240:243], v[30:33]
    v_mfma_f32_16x16x32_bf16 v[34:37], v[148:151], v[244:247], v[34:37]
    v_mfma_f32_16x16x32_bf16 v[38:41], v[152:155], v[244:247], v[38:41]
    v_mfma_f32_16x16x32_bf16 v[42:45], v[148:151], v[248:251], v[42:45]
    v_mfma_f32_16x16x32_bf16 v[46:49], v[152:155], v[248:251], v[46:49]
    v_mov_b32 v228, v100
    v_mov_b32 v229, v101
    v_mov_b32 v230, v102
    v_mov_b32 v231, v103
    v_and_b32 v108, 3, v1
    v_lshlrev_b32 v108, 3, v108
    v_sub_u32 v90, v90, v108
    v_lshlrev_b32 v108, 1, v108
    v_xor_b32 v90, v90, v108
    s_waitcnt vmcnt(0)
    v_and_b32 v87, 1, v0
    v_and_b32 v86, 0xffff, v252
    v_add_u32 v86, v86, v87
    v_mad_u32_u24 v86, v86, 12, v2
    v_lshrrev_b32 v252, 16, v252
    v_sub_u32 v87, v252, v87
    v_add_u32 v87, 1, v87
    v_lshrrev_b32 v87, 1, v87
    v_cmp_lt_u32 s[4:5], 0, v87
    v_cmp_lt_u32 s[6:7], 1, v87
    v_cmp_lt_u32 s[8:9], 2, v87
    v_cmp_lt_u32 s[10:11], 3, v87
    v_cmp_lt_u32 s[12:13], 4, v87
    v_cmp_lt_u32 s[14:15], 5, v87
    v_cmp_lt_u32 s[16:17], 6, v87
    v_cmp_lt_u32 s[18:19], 7, v87
    v_cmp_lt_u32 s[28:29], 8, v87
    s_mov_b64 exec, s[4:5]
    s_cbranch_execz kf_recend
    buffer_load_dwordx3 v[92:94], v86, s[32:35], 0 offen offset:1024
    s_mov_b64 exec, s[6:7]
    s_cbranch_execz kf_recend
    buffer_load_dwordx3 v[96:98], v86, s[32:35], 0 offen offset:1048
    s_mov_b64 exec, s[8:9]
    s_cbranch_execz kf_recend
    buffer_load_dwordx3 v[100:102], v86, s[32:35], 0 offen offset:1072
    s_mov_b64 exec, s[10:11]
    s_cbranch_execz kf_recend
    buffer_load_dwordx3 v[104:106], v86, s[32:35], 0 offen offset:1096
    s_mov_b64 exec, s[12:13]
    s_cbranch_execz kf_recend
    buffer_load_dwordx3 v[108:110], v86, s[32:35], 0 offen offset:1120
    s_mov_b64 exec, s[14:15]
    s_cbranch_execz kf_recend
    buffer_load_dwordx3 v[112:114], v86, s[32:35], 0 offen offset:1144
    s_mov_b64 exec, s[16:17]
    s_cbranch_execz kf_recend
    buffer_load_dwordx3 v[116:118], v86, s[32:35], 0 offen offset:1168
    s_mov_b64 exec, s[18:19]
    s_cbranch_execz kf_recend
    buffer_load_dwordx3 v[120:122], v86, s[32:35], 0 offen offset:1192
kf_recend:
    s_mov_b64 exec, -1
    s_mov_b32 s74, 0xbfb8aa3b
    s_mov_b32 s75, 0xbfb8aa3b
    s_lshl_b32 s55, s98, 9
    s_nop 4
    v_pk_mul_f32 v[26:27], v[26:27], s[74:75]
    v_pk_mul_f32 v[28:29], v[28:29], s[74:75]
    v_pk_mul_f32 v[30:31], v[30:31], s[74:75]
    v_pk_mul_f32 v[32:33], v[32:33], s[74:75]
    v_cvt_pk_bf16_f32 v26, v26, v27
    v_cvt_pk_bf16_f32 v27, v28, v29
    v_cvt_pk_bf16_f32 v28, v30, v31
    v_cvt_pk_bf16_f32 v29, v32, v33
    ds_write_b128 v253, v[26:29] offset:0
    v_pk_mul_f32 v[34:35], v[34:35], s[74:75]
    v_pk_mul_f32 v[36:37], v[36:37], s[74:75]
    v_pk_mul_f32 v[38:39], v[38:39], s[74:75]
    v_pk_mul_f32 v[40:41], v[40:41], s[74:75]
    v_cvt_pk_bf16_f32 v34, v34, v35
    v_cvt_pk_bf16_f32 v35, v36, v37
    v_cvt_pk_bf16_f32 v36, v38, v39
    v_cvt_pk_bf16_f32 v37, v40, v41
    ds_write_b128 v253, v[34:37] offset:9472
    v_pk_mul_f32 v[42:43], v[42:43], s[74:75]
    v_pk_mul_f32 v[44:45], v[44:45], s[74:75]
    v_pk_mul_f32 v[46:47], v[46:47], s[74:75]
    v_pk_mul_f32 v[48:49], v[48:49], s[74:75]
    v_cvt_pk_bf16_f32 v42, v42, v43
    v_cvt_pk_bf16_f32 v43, v44, v45
    v_cvt_pk_bf16_f32 v44, v46, v47
    v_cvt_pk_bf16_f32 v45, v48, v49
    s_mov_b32 exec_lo, 0x00ff00ff
    s_mov_b32 exec_hi, 0x00ff00ff
    ds_write_b128 v253, v[42:45] offset:18944
    s_mov_b64 exec, -1
    v_mov_b32 v30, v58
    v_mov_b32 v31, v59
    v_mov_b32 v34, v60
    v_mov_b32 v35, v61
    s_sub_u32 s20, s64, 3072
    s_subb_u32 s21, s65, 0
    s_or_b32 s21, s21, 33554432
    s_mov_b32 s22, 10192
    s_mov_b32 s23, 0x20000
    v_mov_b32 v164, 0
    v_mov_b32 v165, 0
    v_mov_b32 v166, 0
    v_mov_b32 v167, 0
    s_mov_b32 s47, 0
    s_mov_b32 s48, 0
    s_mov_b32 s30, 0
    s_mov_b32 s38, 0
    s_mov_b32 s39, 0
    s_mov_b32 s31, 146688
    s_cmp_lg_u32 s44, 7
    s_cbranch_scc1 k2_nooh
    v_add_u32 v180, 121984, v3
    ds_write_b128 v180, v[164:167]
    ds_write_b128 v180, v[164:167] offset:1024
    ds_write_b128 v180, v[164:167] offset:2048
    ds_write_b128 v180, v[164:167] offset:3072
    v_mul_u32_u24 v180, 592, v1
    v_mov_b32 v182, 0x3f80
    v_add_u32 v180, 98816, v180
    v_lshl_add_u32 v181, v1, 1, v180
    s_mov_b32 exec_hi, 0xff
    ds_write_b128 v180, v[164:167]
    ds_write_b128 v180, v[164:167] offset:16
    ds_write_b128 v180, v[164:167] offset:32
    ds_write_b128 v180, v[164:167] offset:48
    ds_write_b128 v180, v[164:167] offset:64
    ds_write_b16 v181, v182
    s_mov_b32 exec_hi, -1
k2_nooh:
    s_cmp_lg_u32 s44, 0
    s_cselect_b32 s100, 1, 0
    s_branch k2_first
k2_batch:
    v_mov_b32 v164, 0
    v_mov_b32 v165, 0
    v_mov_b32 v166, 0
    v_mov_b32 v167, 0
    v_lshlrev_b32 v180, 4, v0
    v_add_u32 v180, 146688, v180
    v_mov_b32 v181, 0xa0a0a0a0
    ds_write_b128 v180, v[164:167]
    v_cmp_gt_u32 vcc, 400, v0
    s_and_saveexec_b64 s[74:75], vcc
    ds_write_b128 v180, v[164:167] offset:8192
    s_mov_b64 exec, -1
    v_cmp_gt_u32 vcc, 140, v0
    s_nop 0
    s_nop 0
    v_cndmask_b32 v172, v181, -1, vcc
    v_cmp_gt_u32 vcc, 156, v0
    v_mov_b32 v173, v172
    v_mov_b32 v174, v172
    v_mov_b32 v175, v172
    s_and_saveexec_b64 s[74:75], vcc
    ds_write_b128 v180, v[172:175] offset:14592
    s_mov_b64 exec, -1
    v_bfe_u32 v180, v1, 5, 1
    v_bfe_u32 v181, v1, 3, 1
    v_bfe_u32 v182, v1, 4, 1
    v_lshlrev_b32 v4, 5, v180
    v_lshl_add_u32 v4, v181, 3, v4
    v_lshl_add_u32 v4, v182, 1, v4
    v_bfe_u32 v183, v1, 2, 2
    v_lshl_add_u32 v6, v180, 2, v183
    v_and_b32 v183, 1, v183
    v_lshl_add_u32 v5, v183, 1, v182
    v_and_b32 v180, 1, v1
    v_lshl_add_u32 v5, v5, 1, v180
    v_lshl_add_u32 v5, v5, 1, v181
    v_bfe_u32 v180, v1, 1, 1
    v_lshl_add_u32 v5, v5, 1, v180
    v_lshlrev_b32 v5, 4, v5
    s_waitcnt lgkmcnt(0)
    s_barrier
k2_first:
    v_lshrrev_b32 v182, 5, v1
    v_and_b32 v183, 31, v1
    v_lshlrev_b32 v180, 3, v182
    v_sub_u32 v180, v183, v180
    v_mov_b32 v181, 0x3f80
    v_and_b32 v10, 1, v180
    v_lshlrev_b32 v10, 4, v10
    v_lshlrev_b32 v181, v10, v181
    v_lshrrev_b32 v180, 1, v180
    v_cmp_eq_u32 vcc, 0, v180
    v_cmp_eq_u32 s[74:75], 1, v180
    s_nop 0
    v_cndmask_b32 v148, 0, v181, vcc
    v_cmp_eq_u32 vcc, 2, v180
    s_nop 0
    v_cndmask_b32 v149, 0, v181, s[74:75]
    v_cmp_eq_u32 s[74:75], 3, v180
    s_nop 0
    v_cndmask_b32 v150, 0, v181, vcc
    v_cmp_eq_u32 vcc, 8, v180
    s_nop 0
    v_cndmask_b32 v151, 0, v181, s[74:75]
    v_cmp_eq_u32 s[74:75], 9, v180
    s_nop 0
    v_cndmask_b32 v152, 0, v181, vcc
    v_cmp_eq_u32 vcc, 10, v180
    s_nop 0
    v_cndmask_b32 v153, 0, v181, s[74:75]
    v_cmp_eq_u32 s[74:75], 11, v180
    s_nop 0
    v_cndmask_b32 v154, 0, v181, vcc
    s_nop 0
    v_cndmask_b32 v155, 0, v181, s[74:75]
    s_mov_b32 s68, 148
    s_lshl_b32 s69, s45, 4
    s_lshl_b32 s55, s46, 7
    s_sub_u32 s69, s69, s55
    s_add_u32 s69, s69, 512
    v_mov_b32 v77, v19
    v_mov_b32 v85, v19
    v_mov_b32 v79, v21
    v_mov_b32 v87, v21
    v_mov_b32 v81, v23
    v_mov_b32 v89, v23
    v_mov_b32 v83, v25
    v_mov_b32 v91, v25
    v_mov_b32 v183, 1
    s_waitcnt vmcnt(0)
    s_mov_b64 exec, s[4:5]
    s_cbranch_execz kf_histend
    v_lshrrev_b32 v172, 14, v94
    v_add_u32 v181, 161024, v172
    ds_add_rtn_u32 v156, v181, v183
    s_mov_b64 exec, s[6:7]
    s_cbranch_execz kf_histend
    v_lshrrev_b32 v173, 14, v98
    v_add_u32 v181, 161024, v173
    ds_add_rtn_u32 v157, v181, v183
    s_mov_b64 exec, s[8:9]
    s_cbranch_execz kf_histend
    v_lshrrev_b32 v174, 14, v102
    v_add_u32 v181, 161024, v174
    ds_add_rtn_u32 v158, v181, v183
    s_mov_b64 exec, s[10:11]
    s_cbranch_execz kf_histend
    v_lshrrev_b32 v175, 14, v106
    v_add_u32 v181, 161024, v175
    ds_add_rtn_u32 v159, v181, v183
    s_mov_b64 exec, s[12:13]
    s_cbranch_execz kf_histend
    v_lshrrev_b32 v176, 14, v110
    v_add_u32 v181, 161024, v176
    ds_add_rtn_u32 v160, v181, v183
    s_mov_b64 exec, s[14:15]
    s_cbranch_execz kf_histend
    v_lshrrev_b32 v177, 14, v114
    v_add_u32 v181, 161024, v177
    ds_add_rtn_u32 v161, v181, v183
    s_mov_b64 exec, s[16:17]
    s_cbranch_execz kf_histend
    v_lshrrev_b32 v178, 14, v118
    v_add_u32 v181, 161024, v178
    ds_add_rtn_u32 v162, v181, v183
    s_mov_b64 exec, s[18:19]
    s_cbranch_execz kf_histend
    v_lshrrev_b32 v179, 14, v122
    v_add_u32 v181, 161024, v179
    ds_add_rtn_u32 v163, v181, v183
    s_mov_b64 exec, s[28:29]
    v_mov_b32 v181, 161276
    ds_add_u32 v181, v183
kf_histend:
    s_mov_b64 exec, -1
    v_lshlrev_b32 v180, 2, v1
    v_add_u32 v180, 161024, v180
    s_waitcnt lgkmcnt(0)
    s_nop 0
    s_or_b32 s56, s47, s30
    s_cbranch_scc1 kf_nost9
    s_add_u32 m0, s53, 0
    s_mov_b32 s57, 32768
    buffer_load_dwordx4 v228, s[40:43], s57 offen offset:0 lds
    buffer_load_dwordx4 v229, s[40:43], s57 offen offset:1024 lds
    buffer_load_dwordx4 v230, s[40:43], s57 offen offset:2048 lds
    buffer_load_dwordx4 v231, s[40:43], s57 offen offset:3072 lds
kf_nost9:
    s_barrier
    ds_read_b32 v181, v180
    v_cmp_gt_u32 vcc, 40, v1
    s_or_b32 s56, s47, s30
    s_cbranch_scc1 kf_nost8
    s_add_u32 m0, s53, 8192
    s_mov_b32 s57, 0
    buffer_load_dwordx4 v228, s[40:43], s57 offen offset:0 lds
    buffer_load_dwordx4 v229, s[40:43], s57 offen offset:1024 lds
    buffer_load_dwordx4 v230, s[40:43], s57 offen offset:2048 lds
    buffer_load_dwordx4 v231, s[40:43], s57 offen offset:3072 lds
kf_nost8:
    s_or_b32 s56, s47, s30
    s_cbranch_scc1 kf_nost10
    s_add_u32 m0, s53, 4096
    s_mov_b32 s57, 65536
    buffer_load_dwordx4 v228, s[40:43], s57 offen offset:0 lds
    buffer_load_dwordx4 v229, s[40:43], s57 offen offset:1024 lds
    buffer_load_dwordx4 v230, s[40:43], s57 offen offset:2048 lds
    buffer_load_dwordx4 v231, s[40:43], s57 offen offset:3072 lds
kf_nost10:
    s_cmp_lg_u32 s100, 0
    s_cbranch_scc1 kf_nopk1
    s_and_b32 s55, s2, 7
    s_lshl_b32 s55, s55, 10
    s_add_u32 s55, s55, 3022848
    buffer_load_dwordx4 v[184:187], v3, s[32:35], s55 offen sc1
kf_nopk1:
    s_waitcnt lgkmcnt(0)
    v_readlane_b32 s71, v181, 63
    v_add_u32 v181, 3, v181
    v_lshrrev_b32 v181, 2, v181
    v_cndmask_b32 v181, 0, v181, vcc
    v_mov_b32 v182, v181
    s_lshl_b32 s57, s71, 8
    s_nop 0
    v_add_u32_dpp v182, v182, v182 row_shr:1 row_mask:0xf bank_mask:0xf bound_ctrl:0
    s_nop 1
    v_add_u32_dpp v182, v182, v182 row_shr:2 row_mask:0xf bank_mask:0xf bound_ctrl:0
    s_nop 1
    v_add_u32_dpp v182, v182, v182 row_shr:4 row_mask:0xf bank_mask:0xf bound_ctrl:0
    s_nop 1
    v_add_u32_dpp v182, v182, v182 row_shr:8 row_mask:0xf bank_mask:0xf bound_ctrl:0
    s_nop 1
    v_add_u32_dpp v182, v182, v182 row_bcast:15 row_mask:0xa bank_mask:0xf
    s_nop 1
    v_add_u32_dpp v182, v182, v182 row_bcast:31 row_mask:0xc bank_mask:0xf
    s_nop 0
    v_readlane_b32 s72, v182, 63
    v_sub_u32 v181, v182, v181
    v_add_u32 v182, 7, v181
    v_lshrrev_b32 v182, 3, v182
    s_add_u32 s55, s72, 7
    v_sub_u32 v180, s55, v181
    v_lshrrev_b32 v180, 3, v180
    v_add_u32 v182, v182, v180
    v_lshlrev_b32 v180, 1, v181
    s_add_u32 s55, s72, 0
    v_sad_u32 v180, v180, s55, 0
    v_lshl_add_u32 v182, v182, 5, v180
    v_subrev_u32 v180, 8, v1
    v_lshl_add_u32 v182, v182, 6, v1
    v_cmp_gt_u32 vcc, 25, v180
    s_nop 1
    v_cndmask_b32 v182, -1, v182, vcc
    s_nop 1
    v_min_u32_dpp v182, v182, v182 row_shr:1 row_mask:0xf bank_mask:0xf
    s_nop 1
    v_min_u32_dpp v182, v182, v182 row_shr:2 row_mask:0xf bank_mask:0xf
    s_nop 1
    v_min_u32_dpp v182, v182, v182 row_shr:4 row_mask:0xf bank_mask:0xf
    s_nop 1
    v_min_u32_dpp v182, v182, v182 row_shr:8 row_mask:0xf bank_mask:0xf
    s_nop 1
    v_min_u32_dpp v182, v182, v182 row_bcast:15 row_mask:0xa bank_mask:0xf
    s_nop 1
    v_min_u32_dpp v182, v182, v182 row_bcast:31 row_mask:0xc bank_mask:0xf
    s_nop 0
    v_readlane_b32 s50, v182, 63
    s_and_b32 s50, s50, 63
    s_cmp_lg_u32 s47, 0
    s_cselect_b32 s50, 20, s50
    s_nop 0
    v_readlane_b32 s55, v181, s50
    v_cmp_le_u32 vcc, s50, v1
    s_add_u32 s70, s55, 7
    s_lshr_b32 s70, s70, 3
    s_sub_u32 s71, s72, s55
    s_add_u32 s71, s71, 7
    s_lshr_b32 s71, s71, 3
    s_add_u32 s56, s70, s71
    s_add_u32 s56, s56, s57
    s_cmp_le_u32 s56, 28
    s_cbranch_scc1 k2_fits
    s_mov_b32 s47, 1
    s_branch k2_hentry
k2_fits:
    s_lshl_b32 s56, s70, 3
    s_sub_u32 s56, s56, s55
    v_mov_b32 v182, s56
    v_cndmask_b32 v182, 0, v182, vcc
    v_add_lshl_u32 v181, v181, v182, 2
    ds_bpermute_b32 v164, v172, v181
    ds_bpermute_b32 v165, v173, v181
    s_cmp_eq_u64 s[8:9], 0
    s_cbranch_scc1 kf_bpend
    ds_bpermute_b32 v166, v174, v181
    ds_bpermute_b32 v167, v175, v181
    s_cmp_eq_u64 s[12:13], 0
    s_cbranch_scc1 kf_bpend
    ds_bpermute_b32 v168, v176, v181
    ds_bpermute_b32 v169, v177, v181
    s_cmp_eq_u64 s[16:17], 0
    s_cbranch_scc1 kf_bpend
    ds_bpermute_b32 v170, v178, v181
    ds_bpermute_b32 v171, v179, v181
kf_bpend:
    s_cmp_eq_u32 s45, 0
    s_cselect_b32 s51, s70, s71
    s_cselect_b32 s52, 0, s70
    s_cselect_b32 s56, 0, 192
    s_lshl_b32 s70, s70, 5
    s_lshl_b32 s55, s52, 6
    s_add_u32 s55, s55, s56
    s_add_u32 s55, s55, 161280
    v_add_u32 v4, s55, v4
    s_lshl_b32 s55, s52, 9
    s_add_u32 s55, s55, 146688
    v_add_u32 v5, s55, v5
    v_mov_b32 v9, 121984
    v_cndmask_b32 v5, v9, v5, s[96:97]
    s_lshl_b32 s55, s52, 3
    s_add_u32 s55, s55, 163520
    v_add_u32 v6, s55, v6
    v_mov_b32 v9, 161280
    v_mov_b32 v10, 161472
    s_lshl_b32 s55, s71, 5
    v_mov_b32 v180, s55
    v_cmp_le_u32 vcc, 96, v0
    v_add_u32 v181, s70, v0
    v_add_u32 v182, 10000, v0
    v_cndmask_b32 v180, 0, v180, vcc
    v_cmp_gt_u32 vcc, 192, v0
    v_add_lshl_u32 v180, v180, v181, 1
    v_add_u32 v180, 161280, v180
    s_and_saveexec_b64 s[74:75], vcc
    ds_write_b16 v180, v182
    s_mov_b64 exec, -1
    v_mov_b32 v38, 0x3f80
    v_mov_b32 v39, 0
    s_mov_b32 s55, 163520
    s_waitcnt lgkmcnt(0)
    s_mov_b64 exec, s[4:5]
    s_cbranch_execz kf_scend
    v_add_u32 v156, v156, v164
    v_cmp_gt_u32 vcc, s70, v156
    v_lshrrev_b32 v182, 2, v156
    v_and_b32 v180, 12, v156
    v_cndmask_b32 v181, v10, v9, vcc
    v_add_u32 v182, s55, v182
    v_lshl_add_u32 v181, v156, 1, v181
    v_lshlrev_b32 v180, 2, v180
    ds_write_b16 v181, v94
    ds_write_b8 v182, v172
    v_lshl_add_u32 v156, v156, 4, s31
    v_lshlrev_b64 v[94:95], v180, v[38:39]
    ds_write_b128 v156, v[92:95]
    s_mov_b64 exec, s[6:7]
    s_cbranch_execz kf_scend
    v_add_u32 v157, v157, v165
    v_cmp_gt_u32 vcc, s70, v157
    v_lshrrev_b32 v182, 2, v157
    v_and_b32 v180, 12, v157
    v_cndmask_b32 v181, v10, v9, vcc
    v_add_u32 v182, s55, v182
    v_lshl_add_u32 v181, v157, 1, v181
    v_lshlrev_b32 v180, 2, v180
    ds_write_b16 v181, v98
    ds_write_b8 v182, v173
    v_lshl_add_u32 v157, v157, 4, s31
    v_lshlrev_b64 v[98:99], v180, v[38:39]
    ds_write_b128 v157, v[96:99]
    s_mov_b64 exec, s[8:9]
    s_cbranch_execz kf_scend
    v_add_u32 v158, v158, v166
    v_cmp_gt_u32 vcc, s70, v158
    v_lshrrev_b32 v182, 2, v158
    v_and_b32 v180, 12, v158
    v_cndmask_b32 v181, v10, v9, vcc
    v_add_u32 v182, s55, v182
    v_lshl_add_u32 v181, v158, 1, v181
    v_lshlrev_b32 v180, 2, v180
    ds_write_b16 v181, v102
    ds_write_b8 v182, v174
    v_lshl_add_u32 v158, v158, 4, s31
    v_lshlrev_b64 v[102:103], v180, v[38:39]
    ds_write_b128 v158, v[100:103]
    s_mov_b64 exec, s[10:11]
    s_cbranch_execz kf_scend
    v_add_u32 v159, v159, v167
    v_cmp_gt_u32 vcc, s70, v159
    v_lshrrev_b32 v182, 2, v159
    v_and_b32 v180, 12, v159
    v_cndmask_b32 v181, v10, v9, vcc
    v_add_u32 v182, s55, v182
    v_lshl_add_u32 v181, v159, 1, v181
    v_lshlrev_b32 v180, 2, v180
    ds_write_b16 v181, v106
    ds_write_b8 v182, v175
    v_lshl_add_u32 v159, v159, 4, s31
    v_lshlrev_b64 v[106:107], v180, v[38:39]
    ds_write_b128 v159, v[104:107]
    s_mov_b64 exec, s[12:13]
    s_cbranch_execz kf_scend
    v_add_u32 v160, v160, v168
    v_cmp_gt_u32 vcc, s70, v160
    v_lshrrev_b32 v182, 2, v160
    v_and_b32 v180, 12, v160
    v_cndmask_b32 v181, v10, v9, vcc
    v_add_u32 v182, s55, v182
    v_lshl_add_u32 v181, v160, 1, v181
    v_lshlrev_b32 v180, 2, v180
    ds_write_b16 v181, v110
    ds_write_b8 v182, v176
    v_lshl_add_u32 v160, v160, 4, s31
    v_lshlrev_b64 v[110:111], v180, v[38:39]
    ds_write_b128 v160, v[108:111]
    s_mov_b64 exec, s[14:15]
    s_cbranch_execz kf_scend
    v_add_u32 v161, v161, v169
    v_cmp_gt_u32 vcc, s70, v161
    v_lshrrev_b32 v182, 2, v161
    v_and_b32 v180, 12, v161
    v_cndmask_b32 v181, v10, v9, vcc
    v_add_u32 v182, s55, v182
    v_lshl_add_u32 v181, v161, 1, v181
    v_lshlrev_b32 v180, 2, v180
    ds_write_b16 v181, v114
    ds_write_b8 v182, v177
    v_lshl_add_u32 v161, v161, 4, s31
    v_lshlrev_b64 v[114:115], v180, v[38:39]
    ds_write_b128 v161, v[112:115]
    s_mov_b64 exec, s[16:17]
    s_cbranch_execz kf_scend
    v_add_u32 v162, v162, v170
    v_cmp_gt_u32 vcc, s70, v162
    v_lshrrev_b32 v182, 2, v162
    v_and_b32 v180, 12, v162
    v_cndmask_b32 v181, v10, v9, vcc
    v_add_u32 v182, s55, v182
    v_lshl_add_u32 v181, v162, 1, v181
    v_lshlrev_b32 v180, 2, v180
    ds_write_b16 v181, v118
    ds_write_b8 v182, v178
    v_lshl_add_u32 v162, v162, 4, s31
    v_lshlrev_b64 v[118:119], v180, v[38:39]
    ds_write_b128 v162, v[116:119]
    s_mov_b64 exec, s[18:19]
    s_cbranch_execz kf_scend
    v_add_u32 v163, v163, v171
    v_cmp_gt_u32 vcc, s70, v163
    v_lshrrev_b32 v182, 2, v163
    v_and_b32 v180, 12, v163
    v_cndmask_b32 v181, v10, v9, vcc
    v_add_u32 v182, s55, v182
    v_lshl_add_u32 v181, v163, 1, v181
    v_lshlrev_b32 v180, 2, v180
    ds_write_b16 v181, v122
    ds_write_b8 v182, v179
    v_lshl_add_u32 v163, v163, 4, s31
    v_lshlrev_b64 v[122:123], v180, v[38:39]
    ds_write_b128 v163, v[120:123]
kf_scend:
    s_mov_b64 exec, -1
    s_waitcnt vmcnt(0)
    s_cmp_lg_u32 s30, 0
    s_cbranch_scc1 kf_now1
    s_waitcnt lgkmcnt(4)
    ds_read_b64_tr_b16 v[140:141], v90 offset:0
    ds_read_b64_tr_b16 v[142:143], v90 offset:256
    ds_read_b64_tr_b16 v[144:145], v90 offset:8
    ds_read_b64_tr_b16 v[146:147], v90 offset:264
    ds_read_b64_tr_b16 v[192:193], v90 offset:2048
    ds_read_b64_tr_b16 v[194:195], v90 offset:2304
    ds_read_b64_tr_b16 v[196:197], v90 offset:2056
    ds_read_b64_tr_b16 v[198:199], v90 offset:2312
kf_now1:
    s_cmp_lg_u32 s100, 0
    s_cbranch_scc1 kf_nopeek
    v_and_b32 v184, v184, v185
    v_and_b32 v186, v186, v187
    v_and_b32 v184, v184, v186
    v_cmp_eq_u32 vcc, 1, v184
    s_cmp_eq_u64 vcc, -1
    s_cbranch_scc0 kf_nopeek
    s_mov_b32 s100, 1
kf_nopeek:
    s_cmp_lg_u32 s100, 0
    s_cbranch_scc1 kf_bdone
    s_and_b32 s55, s2, 7
    s_lshl_b32 s55, s55, 10
    s_add_u32 s55, s55, 3022848
    s_mov_b32 s49, 400000
kf_pollB:
    buffer_load_dwordx4 v[168:171], v3, s[32:35], s55 offen sc1
    s_waitcnt vmcnt(0)
    v_and_b32 v168, v168, v169
    v_and_b32 v170, v170, v171
    v_and_b32 v168, v168, v170
    v_cmp_eq_u32 vcc, 1, v168
    s_cmp_eq_u64 vcc, -1
    s_cbranch_scc1 kf_pollB_ok
    s_sleep 1
    s_sub_u32 s49, s49, 1
    s_cbranch_scc0 kf_pollB
kf_pollB_ok:
    s_mov_b32 s100, 1
    s_waitcnt vmcnt(0)
kf_bdone:
    v_mov_b32 v185, v19
    v_mov_b32 v187, v21
    v_mov_b32 v189, v23
    v_mov_b32 v191, v25
    v_mov_b32 v183, v90
    s_waitcnt lgkmcnt(0)
    s_barrier
    ds_read_u16 v76, v4 offset:0
    ds_read_u16 v78, v4 offset:4
    ds_read_u16 v80, v4 offset:16
    ds_read_u16 v82, v4 offset:20
    ds_read_u16 v84, v4 offset:64
    ds_read_u16 v86, v4 offset:68
    ds_read_u16 v88, v4 offset:80
    ds_read_u16 v90, v4 offset:84
    s_mov_b32 m0, s53
    s_waitcnt lgkmcnt(4)
    buffer_load_dwordx4 v[76:77], s[20:23], 0 idxen offen offset:0 lds
    buffer_load_dwordx4 v[78:79], s[20:23], 0 idxen offen offset:1024 lds
    buffer_load_dwordx4 v[80:81], s[20:23], 0 idxen offen offset:2048 lds
    buffer_load_dwordx4 v[82:83], s[20:23], 0 idxen offen offset:3072 lds
    s_cmp_lg_u32 s30, 0
    s_cbranch_scc1 kf_now2
    ds_read_b64_tr_b16 v[200:201], v183 offset:4096
    ds_read_b64_tr_b16 v[202:203], v183 offset:4352
    ds_read_b64_tr_b16 v[204:205], v183 offset:4104
    ds_read_b64_tr_b16 v[206:207], v183 offset:4360
    ds_read_b64_tr_b16 v[208:209], v183 offset:6144
    ds_read_b64_tr_b16 v[210:211], v183 offset:6400
    ds_read_b64_tr_b16 v[212:213], v183 offset:6152
    ds_read_b64_tr_b16 v[214:215], v183 offset:6408
    s_waitcnt lgkmcnt(4)
    ds_read_b64_tr_b16 v[124:125], v183 offset:8192
    ds_read_b64_tr_b16 v[126:127], v183 offset:8448
    ds_read_b64_tr_b16 v[128:129], v183 offset:8200
    ds_read_b64_tr_b16 v[130:131], v183 offset:8456
    ds_read_b64_tr_b16 v[132:133], v183 offset:10240
    ds_read_b64_tr_b16 v[134:135], v183 offset:10496
    ds_read_b64_tr_b16 v[136:137], v183 offset:10248
    ds_read_b64_tr_b16 v[138:139], v183 offset:10504
    s_waitcnt lgkmcnt(0)
    s_add_u32 m0, s53, 8192
    s_mov_b32 s57, 98304
    buffer_load_dwordx4 v228, s[40:43], s57 offen offset:0 lds
    buffer_load_dwordx4 v229, s[40:43], s57 offen offset:1024 lds
    buffer_load_dwordx4 v230, s[40:43], s57 offen offset:2048 lds
    buffer_load_dwordx4 v231, s[40:43], s57 offen offset:3072 lds
kf_now2:
    s_waitcnt lgkmcnt(0)
    s_cmp_eq_u32 s30, 0
    s_cbranch_scc1 kf_dor
    s_add_u32 m0, s53, 4096
    s_nop 0
    buffer_load_dwordx4 v[84:85], s[20:23], 0 idxen offen offset:0 lds
    buffer_load_dwordx4 v[86:87], s[20:23], 0 idxen offen offset:1024 lds
    buffer_load_dwordx4 v[88:89], s[20:23], 0 idxen offen offset:2048 lds
    buffer_load_dwordx4 v[90:91], s[20:23], 0 idxen offen offset:3072 lds
    s_branch kf_nor
kf_dor:
    v_and_b32 v180, 15, v1
    v_lshrrev_b32 v181, 4, v1
    v_xor_b32 v181, v181, v180
    v_lshlrev_b32 v181, 4, v181
    v_lshl_add_u32 v180, v180, 9, v181
    v_add_u32 v156, 126208, v180
    v_xor_b32 v181, 64, v180
    v_add_u32 v157, 126208, v181
    v_xor_b32 v181, 128, v180
    v_add_u32 v158, 126208, v181
    v_xor_b32 v181, 192, v180
    v_add_u32 v159, 126208, v181
    ds_read_b128 v[92:95], v156 offset:0
    ds_read_b128 v[96:99], v156 offset:8192
    ds_read_b128 v[100:103], v156 offset:16384
    ds_read_b128 v[104:107], v157 offset:0
    ds_read_b128 v[108:111], v157 offset:8192
    ds_read_b128 v[112:115], v157 offset:16384
    s_waitcnt lgkmcnt(3)
    v_mfma_f32_16x16x32_bf16 v[232:235], v[124:127], v[92:95], 0
    v_mfma_f32_16x16x32_bf16 v[236:239], v[128:131], v[92:95], 0
    v_mfma_f32_16x16x32_bf16 v[240:243], v[124:127], v[96:99], 0
    v_mfma_f32_16x16x32_bf16 v[244:247], v[128:131], v[96:99], 0
    v_mfma_f32_16x16x32_bf16 v[248:251], v[124:127], v[100:103], 0
    v_mfma_f32_16x16x32_bf16 v[252:255], v[128:131], v[100:103], 0
    ds_read_b128 v[92:95], v158 offset:0
    ds_read_b128 v[96:99], v158 offset:8192
    ds_read_b128 v[100:103], v158 offset:16384
    s_waitcnt lgkmcnt(3)
    v_mfma_f32_16x16x32_bf16 v[232:235], v[132:135], v[104:107], v[232:235]
    v_mfma_f32_16x16x32_bf16 v[236:239], v[136:139], v[104:107], v[236:239]
    v_mfma_f32_16x16x32_bf16 v[240:243], v[132:135], v[108:111], v[240:243]
    v_mfma_f32_16x16x32_bf16 v[244:247], v[136:139], v[108:111], v[244:247]
    v_mfma_f32_16x16x32_bf16 v[248:251], v[132:135], v[112:115], v[248:251]
    v_mfma_f32_16x16x32_bf16 v[252:255], v[136:139], v[112:115], v[252:255]
    ds_read_b128 v[104:107], v159 offset:0
    ds_read_b128 v[108:111], v159 offset:8192
    ds_read_b128 v[112:115], v159 offset:16384
    s_waitcnt lgkmcnt(3)
    s_add_u32 m0, s53, 4096
    s_nop 0
    buffer_load_dwordx4 v[84:85], s[20:23], 0 idxen offen offset:0 lds
    buffer_load_dwordx4 v[86:87], s[20:23], 0 idxen offen offset:1024 lds
    buffer_load_dwordx4 v[88:89], s[20:23], 0 idxen offen offset:2048 lds
    buffer_load_dwordx4 v[90:91], s[20:23], 0 idxen offen offset:3072 lds
    v_mfma_f32_16x16x32_bf16 v[232:235], v[140:143], v[92:95], v[232:235]
    v_mfma_f32_16x16x32_bf16 v[236:239], v[144:147], v[92:95], v[236:239]
    v_mfma_f32_16x16x32_bf16 v[240:243], v[140:143], v[96:99], v[240:243]
    v_mfma_f32_16x16x32_bf16 v[244:247], v[144:147], v[96:99], v[244:247]
    v_mfma_f32_16x16x32_bf16 v[248:251], v[140:143], v[100:103], v[248:251]
    v_mfma_f32_16x16x32_bf16 v[252:255], v[144:147], v[100:103], v[252:255]
    ds_read_b128 v[92:95], v156 offset:256
    ds_read_b128 v[96:99], v156 offset:8448
    ds_read_b128 v[100:103], v156 offset:16640
    s_waitcnt lgkmcnt(3)
    v_mfma_f32_16x16x32_bf16 v[232:235], v[192:195], v[104:107], v[232:235]
    v_mfma_f32_16x16x32_bf16 v[236:239], v[196:199], v[104:107], v[236:239]
    v_mfma_f32_16x16x32_bf16 v[240:243], v[192:195], v[108:111], v[240:243]
    v_mfma_f32_16x16x32_bf16 v[244:247], v[196:199], v[108:111], v[244:247]
    v_mfma_f32_16x16x32_bf16 v[248:251], v[192:195], v[112:115], v[248:251]
    v_mfma_f32_16x16x32_bf16 v[252:255], v[196:199], v[112:115], v[252:255]
    ds_read_b128 v[104:107], v157 offset:256
    ds_read_b128 v[108:111], v157 offset:8448
    ds_read_b128 v[112:115], v157 offset:16640
    s_waitcnt lgkmcnt(3)
    v_mfma_f32_16x16x32_bf16 v[232:235], v[200:203], v[92:95], v[232:235]
    v_mfma_f32_16x16x32_bf16 v[236:239], v[204:207], v[92:95], v[236:239]
    v_mfma_f32_16x16x32_bf16 v[240:243], v[200:203], v[96:99], v[240:243]
    v_mfma_f32_16x16x32_bf16 v[244:247], v[204:207], v[96:99], v[244:247]
    v_mfma_f32_16x16x32_bf16 v[248:251], v[200:203], v[100:103], v[248:251]
    v_mfma_f32_16x16x32_bf16 v[252:255], v[204:207], v[100:103], v[252:255]
    ds_read_b128 v[92:95], v158 offset:256
    ds_read_b128 v[96:99], v158 offset:8448
    ds_read_b128 v[100:103], v158 offset:16640
    s_waitcnt lgkmcnt(3)
    s_waitcnt vmcnt(4)
    ds_read_b64_tr_b16 v[216:217], v183 offset:8192
    ds_read_b64_tr_b16 v[218:219], v183 offset:8448
    ds_read_b64_tr_b16 v[220:221], v183 offset:8200
    ds_read_b64_tr_b16 v[222:223], v183 offset:8456
    ds_read_b64_tr_b16 v[224:225], v183 offset:10240
    ds_read_b64_tr_b16 v[226:227], v183 offset:10496
    ds_read_b64_tr_b16 v[228:229], v183 offset:10248
    ds_read_b64_tr_b16 v[230:231], v183 offset:10504
    s_waitcnt lgkmcnt(8)
    v_mfma_f32_16x16x32_bf16 v[232:235], v[208:211], v[104:107], v[232:235]
    v_mfma_f32_16x16x32_bf16 v[236:239], v[212:215], v[104:107], v[236:239]
    v_mfma_f32_16x16x32_bf16 v[240:243], v[208:211], v[108:111], v[240:243]
    v_mfma_f32_16x16x32_bf16 v[244:247], v[212:215], v[108:111], v[244:247]
    v_mfma_f32_16x16x32_bf16 v[248:251], v[208:211], v[112:115], v[248:251]
    v_mfma_f32_16x16x32_bf16 v[252:255], v[212:215], v[112:115], v[252:255]
    ds_read_b128 v[104:107], v159 offset:256
    ds_read_b128 v[108:111], v159 offset:8448
    ds_read_b128 v[112:115], v159 offset:16640
    s_waitcnt lgkmcnt(3)
    v_mfma_f32_16x16x32_bf16 v[232:235], v[216:219], v[92:95], v[232:235]
    v_mfma_f32_16x16x32_bf16 v[236:239], v[220:223], v[92:95], v[236:239]
    v_mfma_f32_16x16x32_bf16 v[240:243], v[216:219], v[96:99], v[240:243]
    v_mfma_f32_16x16x32_bf16 v[244:247], v[220:223], v[96:99], v[244:247]
    v_mfma_f32_16x16x32_bf16 v[248:251], v[216:219], v[100:103], v[248:251]
    v_mfma_f32_16x16x32_bf16 v[252:255], v[220:223], v[100:103], v[252:255]
    s_waitcnt lgkmcnt(0)
    v_mfma_f32_16x16x32_bf16 v[232:235], v[224:227], v[104:107], v[232:235]
    v_mfma_f32_16x16x32_bf16 v[236:239], v[228:231], v[104:107], v[236:239]
    v_mfma_f32_16x16x32_bf16 v[240:243], v[224:227], v[108:111], v[240:243]
    v_mfma_f32_16x16x32_bf16 v[244:247], v[228:231], v[108:111], v[244:247]
    v_mfma_f32_16x16x32_bf16 v[248:251], v[224:227], v[112:115], v[248:251]
    v_mfma_f32_16x16x32_bf16 v[252:255], v[228:231], v[112:115], v[252:255]
    s_mov_b32 s30, 1
    v_mov_b32 v180, 163784
    v_mov_b32 v181, 1
    s_mov_b64 exec, 1
    ds_add_u32 v180, v181
    s_mov_b64 exec, -1
    v_mov_b32 v220, v156
    v_mov_b32 v221, v157
    v_mov_b32 v222, v158
    v_mov_b32 v223, v159
    s_mov_b32 s74, 0xbfb8aa3b
    s_mov_b32 s75, 0xbfb8aa3b
    v_and_b32 v180, 31, v1
    s_lshl_b32 s56, s45, 3
    v_add_u32 v180, s56, v180
    v_and_b32 v182, 15, v180
    s_lshl_b32 s56, s46, 3
    v_xor_b32 v182, s56, v182
    v_lshlrev_b32 v182, 4, v182
    v_lshl_add_u32 v182, v180, 9, v182
    v_lshrrev_b32 v181, 5, v1
    v_lshl_add_u32 v182, v181, 3, v182
    v_add_u32 v224, 126208, v182
    v_and_b32 v180, 15, v1
    v_lshrrev_b32 v181, 4, v1
    v_lshlrev_b32 v181, 4, v181
    v_lshl_add_u32 v226, v180, 9, v181
    v_mov_b32 v227, 163784
    v_mov_b32 v228, 0
    v_pk_mul_f32 v[232:233], v[232:233], s[74:75]
    v_pk_mul_f32 v[234:235], v[234:235], s[74:75]
    v_pk_mul_f32 v[236:237], v[236:237], s[74:75]
    v_pk_mul_f32 v[238:239], v[238:239], s[74:75]
    v_pk_mul_f32 v[240:241], v[240:241], s[74:75]
    v_pk_mul_f32 v[242:243], v[242:243], s[74:75]
    v_pk_mul_f32 v[244:245], v[244:245], s[74:75]
    v_pk_mul_f32 v[246:247], v[246:247], s[74:75]
    v_pk_mul_f32 v[248:249], v[248:249], s[74:75]
    v_pk_mul_f32 v[250:251], v[250:251], s[74:75]
    v_pk_mul_f32 v[252:253], v[252:253], s[74:75]
    v_pk_mul_f32 v[254:255], v[254:255], s[74:75]
kf_nor:
    v_and_b32 v180, 31, v1
    s_lshl_b32 s56, s45, 3
    v_add_u32 v180, s56, v180
    v_cmp_gt_u32 vcc, s50, v180
    s_cmp_eq_u32 s45, 0
    s_cselect_b64 s[36:37], 0, -1
    s_xor_b64 s[36:37], s[36:37], vcc
    s_add_u32 s57, s99, 12288
    buffer_load_dwordx4 v[204:207], v3, s[32:35], s57 offen offset:0
    s_add_u32 s57, s99, 12288
    buffer_load_dwordx4 v[208:211], v3, s[32:35], s57 offen offset:1024
    s_add_u32 s57, s99, 12288
    buffer_load_dwordx4 v[212:215], v3, s[32:35], s57 offen offset:2048
    s_add_u32 s57, s99, 12288
    buffer_load_dwordx4 v[216:219], v3, s[32:35], s57 offen offset:3072
    v_mov_b32 v124, 0
    v_mov_b32 v128, 1.0
    v_mov_b32 v125, 0
    v_mov_b32 v129, 1.0
    v_mov_b32 v126, 0
    v_mov_b32 v130, 1.0
    v_mov_b32 v127, 0
    v_mov_b32 v131, 1.0
    v_mov_b32 v156, 0
    v_mov_b32 v157, 0
    v_mov_b32 v160, 0
    v_mov_b32 v161, 0
    v_mov_b32 v164, 0
    v_mov_b32 v165, 0
    s_cmp_eq_u32 s51, 0
    s_cbranch_scc1 k2_notile
    ds_read_u8 v9, v6
    ds_read_b128 v[26:29], v5
    s_waitcnt vmcnt(8)
    ds_read_b128 v[132:135], v14
    ds_read_b128 v[136:139], v15
    ds_read_b128 v[140:143], v16
    ds_read_b128 v[144:147], v17
    s_waitcnt lgkmcnt(5)
    v_mad_u32_u24 v10, v9, s68, v7
    v_add_u32 v11, s69, v10
    ds_read_u8 v9, v6 offset:8
    ds_read_b64_tr_b16 v[32:33], v10
    ds_read_b64_tr_b16 v[36:37], v10 offset:64
    ds_read_u16 v184, v4 offset:128
    ds_read_u16 v186, v4 offset:132
    ds_read_u16 v188, v4 offset:144
    ds_read_u16 v190, v4 offset:148
    ds_read_u16 v18, v4 offset:192
    ds_read_u16 v20, v4 offset:196
    ds_read_u16 v22, v4 offset:208
    ds_read_u16 v24, v4 offset:212
    s_sub_u32 s54, s51, 1
    s_waitcnt lgkmcnt(9)
    v_mfma_f32_32x32x16_bf16 v[76:91], v[26:29], v[30:33], 0
    v_mfma_f32_32x32x16_bf16 v[76:91], v[132:135], v[148:151], v[76:91]
    v_mfma_f32_32x32x16_bf16 v[76:91], v[136:139], v[152:155], v[76:91]
    s_nop 7
    s_nop 3
    s_cmp_lg_u32 s39, 0
    s_cbranch_scc1 k2_safe
    s_cmp_lg_u32 s45, 0
    s_cbranch_scc1 k2_g1
    s_setprio 0
    s_waitcnt lgkmcnt(0)
    s_cmp_lg_u32 s38, 0
    s_cbranch_scc1 kf_f0A_a
    v_mfma_f32_32x32x8_bf16 v[44:59], v[156:157], v[164:165], 0
kf_f0A_a:
    v_exp_f32 v108, v76
    v_exp_f32 v109, v77
    v_exp_f32 v110, v78
    v_exp_f32 v111, v79
    v_mfma_f32_32x32x16_bf16 v[92:107], v[26:29], v[34:37], 0
    v_exp_f32 v112, v80
    v_exp_f32 v113, v81
    v_exp_f32 v114, v82
    v_exp_f32 v115, v83
    v_mfma_f32_32x32x16_bf16 v[92:107], v[140:143], v[148:151], v[92:107]
    v_max3_f32 v228, v228, v128, v129
    v_exp_f32 v116, v84
    v_exp_f32 v117, v85
    v_exp_f32 v118, v86
    v_exp_f32 v119, v87
    v_mfma_f32_32x32x16_bf16 v[92:107], v[144:147], v[152:155], v[92:107]
    v_mad_u32_u24 v10, v9, s68, v7
    v_add_u32 v12, s69, v10
    v_exp_f32 v120, v88
    v_exp_f32 v121, v89
    v_exp_f32 v122, v90
    v_exp_f32 v123, v91
    v_rcp_f32 v128, v128
    v_rcp_f32 v129, v129
    s_setprio 2
    s_waitcnt vmcnt(4)
    v_pk_add_f32 v[110:111], v[110:111], 1.0 op_sel_hi:[1,0]
    ds_read_b128 v[132:135], v14 offset:4096
    v_pk_add_f32 v[114:115], v[114:115], 1.0 op_sel_hi:[1,0]
    ds_read_b128 v[136:139], v15 offset:4096
    v_pk_add_f32 v[118:119], v[118:119], 1.0 op_sel_hi:[1,0]
    ds_read_b64_tr_b16 v[32:33], v10
    v_pk_add_f32 v[122:123], v[122:123], 1.0 op_sel_hi:[1,0]
    ds_read_b128 v[26:29], v5 offset:512
    v_pk_mul_f32 v[124:125], v[124:125], v[128:129]
    s_add_u32 m0, s53, 8192
    v_pk_mul_f32 v[126:127], v[126:127], v[128:129]
    buffer_load_dwordx4 v[184:185], s[20:23], 0 idxen offen offset:0 lds
    v_pk_fma_f32 v[76:77], v[76:77], v[110:111], v[78:79]
    v_pk_fma_f32 v[80:81], v[80:81], v[114:115], v[82:83]
    v_pk_fma_f32 v[84:85], v[84:85], v[118:119], v[86:87]
    buffer_load_dwordx4 v[186:187], s[20:23], 0 idxen offen offset:1024 lds
    v_pk_fma_f32 v[88:89], v[88:89], v[122:123], v[90:91]
    v_cvt_pk_bf16_f32 v162, v124, v125
    v_cvt_pk_bf16_f32 v163, v126, v127
    buffer_load_dwordx4 v[188:189], s[20:23], 0 idxen offen offset:2048 lds
    v_pk_fma_f32 v[76:77], v[78:79], v[108:109], v[76:77]
    v_pk_fma_f32 v[80:81], v[82:83], v[112:113], v[80:81]
    v_pk_fma_f32 v[84:85], v[86:87], v[116:117], v[84:85]
    buffer_load_dwordx4 v[190:191], s[20:23], 0 idxen offen offset:3072 lds
    v_pk_fma_f32 v[88:89], v[90:91], v[120:121], v[88:89]
    v_pk_fma_f32 v[108:109], v[108:109], v[110:111], v[110:111]
    s_mov_b32 m0, s53
    v_pk_fma_f32 v[112:113], v[112:113], v[114:115], v[114:115]
    buffer_load_dwordx4 v[18:19], s[20:23], 0 idxen offen offset:0 lds
    v_pk_fma_f32 v[116:117], v[116:117], v[118:119], v[118:119]
    v_pk_fma_f32 v[120:121], v[120:121], v[122:123], v[122:123]
    v_pk_mul_f32 v[124:125], v[76:77], v[112:113]
    buffer_load_dwordx4 v[20:21], s[20:23], 0 idxen offen offset:1024 lds
    v_pk_mul_f32 v[126:127], v[84:85], v[120:121]
    v_pk_mul_f32 v[128:129], v[108:109], v[112:113]
    v_pk_mul_f32 v[130:131], v[116:117], v[120:121]
    buffer_load_dwordx4 v[22:23], s[20:23], 0 idxen offen offset:2048 lds
    v_pk_fma_f32 v[124:125], v[80:81], v[108:109], v[124:125]
    v_pk_fma_f32 v[126:127], v[88:89], v[116:117], v[126:127]
    v_pk_mul_f32 v[124:125], v[124:125], v[130:131]
    buffer_load_dwordx4 v[24:25], s[20:23], 0 idxen offen offset:3072 lds
    v_pk_mul_f32 v[126:127], v[126:127], v[128:129]
    v_pk_mul_f32 v[128:129], v[128:129], v[130:131]
    s_setprio 0
    s_waitcnt lgkmcnt(0)
    s_cmp_lg_u32 s38, 0
    s_cbranch_scc1 kf_f0B_a
    v_mfma_f32_32x32x8_bf16 v[60:75], v[160:161], v[164:165], 0
kf_f0B_a:
    v_exp_f32 v108, v92
    v_exp_f32 v109, v93
    v_exp_f32 v110, v94
    v_exp_f32 v111, v95
    v_mfma_f32_32x32x16_bf16 v[76:91], v[26:29], v[30:33], 0
    v_exp_f32 v112, v96
    v_exp_f32 v113, v97
    v_exp_f32 v114, v98
    v_exp_f32 v115, v99
    v_mfma_f32_32x32x16_bf16 v[76:91], v[132:135], v[148:151], v[76:91]
    v_max3_f32 v228, v228, v128, v129
    v_exp_f32 v116, v100
    v_exp_f32 v117, v101
    v_exp_f32 v118, v102
    v_exp_f32 v119, v103
    v_mfma_f32_32x32x16_bf16 v[76:91], v[136:139], v[152:155], v[76:91]
    v_exp_f32 v120, v104
    v_exp_f32 v121, v105
    v_exp_f32 v122, v106
    v_exp_f32 v123, v107
    v_rcp_f32 v128, v128
    v_rcp_f32 v129, v129
    s_setprio 2
    ds_read_b128 v[140:143], v16 offset:4096
    v_pk_add_f32 v[110:111], v[110:111], 1.0 op_sel_hi:[1,0]
    v_pk_add_f32 v[114:115], v[114:115], 1.0 op_sel_hi:[1,0]
    ds_read_b128 v[144:147], v17 offset:4096
    v_pk_add_f32 v[118:119], v[118:119], 1.0 op_sel_hi:[1,0]
    v_pk_add_f32 v[122:123], v[122:123], 1.0 op_sel_hi:[1,0]
    ds_read_b64_tr_b16 v[36:37], v10 offset:64
    v_pk_mul_f32 v[124:125], v[124:125], v[128:129]
    v_pk_mul_f32 v[126:127], v[126:127], v[128:129]
    ds_read_b64_tr_b16 v[164:165], v11
    v_pk_fma_f32 v[92:93], v[92:93], v[110:111], v[94:95]
    v_pk_fma_f32 v[96:97], v[96:97], v[114:115], v[98:99]
    ds_read_u8 v9, v6 offset:16
    v_pk_fma_f32 v[100:101], v[100:101], v[118:119], v[102:103]
    v_pk_fma_f32 v[104:105], v[104:105], v[122:123], v[106:107]
    ds_read_u16 v18, v4 offset:256
    v_cvt_pk_bf16_f32 v156, v124, v125
    v_cvt_pk_bf16_f32 v157, v126, v127
    ds_read_u16 v20, v4 offset:260
    v_pk_fma_f32 v[92:93], v[94:95], v[108:109], v[92:93]
    v_pk_fma_f32 v[96:97], v[98:99], v[112:113], v[96:97]
    ds_read_u16 v22, v4 offset:272
    v_pk_fma_f32 v[100:101], v[102:103], v[116:117], v[100:101]
    v_pk_fma_f32 v[104:105], v[106:107], v[120:121], v[104:105]
    ds_read_u16 v24, v4 offset:276
    v_pk_fma_f32 v[108:109], v[108:109], v[110:111], v[110:111]
    v_pk_fma_f32 v[112:113], v[112:113], v[114:115], v[114:115]
    v_pk_fma_f32 v[116:117], v[116:117], v[118:119], v[118:119]
    v_pk_fma_f32 v[120:121], v[120:121], v[122:123], v[122:123]
    v_pk_mul_f32 v[124:125], v[92:93], v[112:113]
    v_pk_mul_f32 v[126:127], v[100:101], v[120:121]
    v_pk_mul_f32 v[128:129], v[108:109], v[112:113]
    v_pk_mul_f32 v[130:131], v[116:117], v[120:121]
    v_pk_fma_f32 v[124:125], v[96:97], v[108:109], v[124:125]
    v_pk_fma_f32 v[126:127], v[104:105], v[116:117], v[126:127]
    s_mov_b32 s38, 1
    v_pk_mul_f32 v[124:125], v[124:125], v[130:131]
    v_pk_mul_f32 v[126:127], v[126:127], v[128:129]
    s_sub_u32 s54, s54, 1
    v_pk_mul_f32 v[128:129], v[128:129], v[130:131]
    s_cbranch_scc1 k2_drain
k2_loop0:
    s_setprio 0
    s_waitcnt lgkmcnt(0)
    v_mfma_f32_32x32x16_bf16 v[92:107], v[26:29], v[34:37], 0
    v_exp_f32 v108, v76
    v_exp_f32 v109, v77
    v_exp_f32 v110, v78
    v_exp_f32 v111, v79
    v_exp_f32 v112, v80
    v_exp_f32 v113, v81
    v_mfma_f32_32x32x16_bf16 v[92:107], v[140:143], v[148:151], v[92:107]
    v_max3_f32 v228, v228, v128, v129
    v_exp_f32 v114, v82
    v_exp_f32 v115, v83
    v_exp_f32 v116, v84
    v_exp_f32 v117, v85
    v_exp_f32 v118, v86
    v_exp_f32 v119, v87
    v_mfma_f32_32x32x16_bf16 v[92:107], v[144:147], v[152:155], v[92:107]
    v_mad_u32_u24 v10, v9, s68, v7
    v_add_u32 v13, s69, v10
    v_exp_f32 v120, v88
    v_exp_f32 v121, v89
    v_exp_f32 v122, v90
    v_exp_f32 v123, v91
    v_rcp_f32 v128, v128
    v_rcp_f32 v129, v129
    s_setprio 2
    s_waitcnt vmcnt(4)
    v_pk_add_f32 v[110:111], v[110:111], 1.0 op_sel_hi:[1,0]
    ds_read_b128 v[132:135], v14 offset:8192
    v_pk_add_f32 v[114:115], v[114:115], 1.0 op_sel_hi:[1,0]
    ds_read_b128 v[136:139], v15 offset:8192
    v_pk_add_f32 v[118:119], v[118:119], 1.0 op_sel_hi:[1,0]
    ds_read_b64_tr_b16 v[32:33], v10
    v_pk_add_f32 v[122:123], v[122:123], 1.0 op_sel_hi:[1,0]
    ds_read_b128 v[26:29], v5 offset:1024
    v_pk_mul_f32 v[124:125], v[124:125], v[128:129]
    s_add_u32 m0, s53, 4096
    v_pk_mul_f32 v[126:127], v[126:127], v[128:129]
    v_pk_fma_f32 v[76:77], v[76:77], v[110:111], v[78:79]
    buffer_load_dwordx4 v[18:19], s[20:23], 0 idxen offen offset:0 lds
    v_pk_fma_f32 v[80:81], v[80:81], v[114:115], v[82:83]
    v_pk_fma_f32 v[84:85], v[84:85], v[118:119], v[86:87]
    v_pk_fma_f32 v[88:89], v[88:89], v[122:123], v[90:91]
    v_cvt_pk_bf16_f32 v160, v124, v125
    v_cvt_pk_bf16_f32 v161, v126, v127
    v_pk_fma_f32 v[76:77], v[78:79], v[108:109], v[76:77]
    v_pk_fma_f32 v[80:81], v[82:83], v[112:113], v[80:81]
    buffer_load_dwordx4 v[20:21], s[20:23], 0 idxen offen offset:1024 lds
    v_pk_fma_f32 v[84:85], v[86:87], v[116:117], v[84:85]
    v_pk_fma_f32 v[88:89], v[90:91], v[120:121], v[88:89]
    v_pk_fma_f32 v[108:109], v[108:109], v[110:111], v[110:111]
    v_pk_fma_f32 v[112:113], v[112:113], v[114:115], v[114:115]
    v_pk_fma_f32 v[116:117], v[116:117], v[118:119], v[118:119]
    v_pk_fma_f32 v[120:121], v[120:121], v[122:123], v[122:123]
    v_pk_mul_f32 v[124:125], v[76:77], v[112:113]
    buffer_load_dwordx4 v[22:23], s[20:23], 0 idxen offen offset:2048 lds
    v_pk_mul_f32 v[126:127], v[84:85], v[120:121]
    v_pk_mul_f32 v[128:129], v[108:109], v[112:113]
    v_pk_mul_f32 v[130:131], v[116:117], v[120:121]
    v_pk_fma_f32 v[124:125], v[80:81], v[108:109], v[124:125]
    v_pk_fma_f32 v[126:127], v[88:89], v[116:117], v[126:127]
    v_pk_mul_f32 v[124:125], v[124:125], v[130:131]
    v_pk_mul_f32 v[126:127], v[126:127], v[128:129]
    buffer_load_dwordx4 v[24:25], s[20:23], 0 idxen offen offset:3072 lds
    v_pk_mul_f32 v[128:129], v[128:129], v[130:131]
    s_setprio 0
    s_waitcnt lgkmcnt(0)
    v_mfma_f32_32x32x16_bf16 v[76:91], v[26:29], v[30:33], 0
    v_exp_f32 v108, v92
    v_exp_f32 v109, v93
    v_exp_f32 v110, v94
    v_exp_f32 v111, v95
    v_exp_f32 v112, v96
    v_exp_f32 v113, v97
    v_mfma_f32_32x32x16_bf16 v[76:91], v[132:135], v[148:151], v[76:91]
    v_max3_f32 v228, v228, v128, v129
    v_exp_f32 v114, v98
    v_exp_f32 v115, v99
    v_exp_f32 v116, v100
    v_exp_f32 v117, v101
    v_exp_f32 v118, v102
    v_exp_f32 v119, v103
    v_mfma_f32_32x32x16_bf16 v[76:91], v[136:139], v[152:155], v[76:91]
    v_exp_f32 v120, v104
    v_exp_f32 v121, v105
    v_exp_f32 v122, v106
    v_exp_f32 v123, v107
    v_rcp_f32 v128, v128
    v_rcp_f32 v129, v129
    s_setprio 2
    ds_read_b128 v[140:143], v16 offset:8192
    v_pk_add_f32 v[110:111], v[110:111], 1.0 op_sel_hi:[1,0]
    v_pk_add_f32 v[114:115], v[114:115], 1.0 op_sel_hi:[1,0]
    ds_read_b128 v[144:147], v17 offset:8192
    v_pk_add_f32 v[118:119], v[118:119], 1.0 op_sel_hi:[1,0]
    v_pk_add_f32 v[122:123], v[122:123], 1.0 op_sel_hi:[1,0]
    ds_read_b64_tr_b16 v[36:37], v10 offset:64
    v_pk_mul_f32 v[124:125], v[124:125], v[128:129]
    v_pk_mul_f32 v[126:127], v[126:127], v[128:129]
    ds_read_b64_tr_b16 v[166:167], v12
    v_pk_fma_f32 v[92:93], v[92:93], v[110:111], v[94:95]
    v_pk_fma_f32 v[96:97], v[96:97], v[114:115], v[98:99]
    ds_read_u8 v9, v6 offset:24
    v_pk_fma_f32 v[100:101], v[100:101], v[118:119], v[102:103]
    v_pk_fma_f32 v[104:105], v[104:105], v[122:123], v[106:107]
    ds_read_u16 v18, v4 offset:320
    v_cvt_pk_bf16_f32 v158, v124, v125
    v_cvt_pk_bf16_f32 v159, v126, v127
    ds_read_u16 v20, v4 offset:324
    v_pk_fma_f32 v[92:93], v[94:95], v[108:109], v[92:93]
    v_pk_fma_f32 v[96:97], v[98:99], v[112:113], v[96:97]
    ds_read_u16 v22, v4 offset:336
    v_pk_fma_f32 v[100:101], v[102:103], v[116:117], v[100:101]
    v_pk_fma_f32 v[104:105], v[106:107], v[120:121], v[104:105]
    ds_read_u16 v24, v4 offset:340
    v_pk_fma_f32 v[108:109], v[108:109], v[110:111], v[110:111]
    v_pk_fma_f32 v[112:113], v[112:113], v[114:115], v[114:115]
    v_pk_fma_f32 v[116:117], v[116:117], v[118:119], v[118:119]
    v_pk_fma_f32 v[120:121], v[120:121], v[122:123], v[122:123]
    v_pk_mul_f32 v[124:125], v[92:93], v[112:113]
    v_pk_mul_f32 v[126:127], v[100:101], v[120:121]
    v_pk_mul_f32 v[128:129], v[108:109], v[112:113]
    v_pk_mul_f32 v[130:131], v[116:117], v[120:121]
    v_pk_fma_f32 v[124:125], v[96:97], v[108:109], v[124:125]
    v_pk_fma_f32 v[126:127], v[104:105], v[116:117], v[126:127]
    v_pk_mul_f32 v[124:125], v[124:125], v[130:131]
    v_pk_mul_f32 v[126:127], v[126:127], v[128:129]
    s_sub_u32 s54, s54, 1
    v_pk_mul_f32 v[128:129], v[128:129], v[130:131]
    s_cbranch_scc1 k2_drain1
    s_setprio 1
    s_waitcnt lgkmcnt(0)
    v_mfma_f32_32x32x16_bf16 v[44:59], v[156:159], v[164:167], v[44:59]
    v_exp_f32 v108, v76
    v_exp_f32 v109, v77
    v_exp_f32 v110, v78
    v_exp_f32 v111, v79
    v_mfma_f32_32x32x16_bf16 v[92:107], v[26:29], v[34:37], 0
    v_exp_f32 v112, v80
    v_exp_f32 v113, v81
    v_exp_f32 v114, v82
    v_exp_f32 v115, v83
    v_mfma_f32_32x32x16_bf16 v[92:107], v[140:143], v[148:151], v[92:107]
    v_max3_f32 v228, v228, v128, v129
    v_exp_f32 v116, v84
    v_exp_f32 v117, v85
    v_exp_f32 v118, v86
    v_exp_f32 v119, v87
    v_mfma_f32_32x32x16_bf16 v[92:107], v[144:147], v[152:155], v[92:107]
    v_mad_u32_u24 v10, v9, s68, v7
    v_add_u32 v11, s69, v10
    v_exp_f32 v120, v88
    v_exp_f32 v121, v89
    v_exp_f32 v122, v90
    v_exp_f32 v123, v91
    v_rcp_f32 v128, v128
    v_rcp_f32 v129, v129
    s_setprio 3
    s_waitcnt vmcnt(4)
    v_pk_add_f32 v[110:111], v[110:111], 1.0 op_sel_hi:[1,0]
    ds_read_b128 v[132:135], v14 offset:0
    v_pk_add_f32 v[114:115], v[114:115], 1.0 op_sel_hi:[1,0]
    ds_read_b128 v[136:139], v15 offset:0
    v_pk_add_f32 v[118:119], v[118:119], 1.0 op_sel_hi:[1,0]
    ds_read_b64_tr_b16 v[32:33], v10
    v_pk_add_f32 v[122:123], v[122:123], 1.0 op_sel_hi:[1,0]
    ds_read_b128 v[26:29], v5 offset:1536
    v_pk_mul_f32 v[124:125], v[124:125], v[128:129]
    s_add_u32 m0, s53, 8192
    v_pk_mul_f32 v[126:127], v[126:127], v[128:129]
    v_pk_fma_f32 v[76:77], v[76:77], v[110:111], v[78:79]
    buffer_load_dwordx4 v[18:19], s[20:23], 0 idxen offen offset:0 lds
    v_pk_fma_f32 v[80:81], v[80:81], v[114:115], v[82:83]
    v_pk_fma_f32 v[84:85], v[84:85], v[118:119], v[86:87]
    v_pk_fma_f32 v[88:89], v[88:89], v[122:123], v[90:91]
    v_cvt_pk_bf16_f32 v162, v124, v125
    v_cvt_pk_bf16_f32 v163, v126, v127
    v_pk_fma_f32 v[76:77], v[78:79], v[108:109], v[76:77]
    v_pk_fma_f32 v[80:81], v[82:83], v[112:113], v[80:81]
    buffer_load_dwordx4 v[20:21], s[20:23], 0 idxen offen offset:1024 lds
    v_pk_fma_f32 v[84:85], v[86:87], v[116:117], v[84:85]
    v_pk_fma_f32 v[88:89], v[90:91], v[120:121], v[88:89]
    v_pk_fma_f32 v[108:109], v[108:109], v[110:111], v[110:111]
    v_pk_fma_f32 v[112:113], v[112:113], v[114:115], v[114:115]
    v_pk_fma_f32 v[116:117], v[116:117], v[118:119], v[118:119]
    v_pk_fma_f32 v[120:121], v[120:121], v[122:123], v[122:123]
    v_pk_mul_f32 v[124:125], v[76:77], v[112:113]
    buffer_load_dwordx4 v[22:23], s[20:23], 0 idxen offen offset:2048 lds
    v_pk_mul_f32 v[126:127], v[84:85], v[120:121]
    v_pk_mul_f32 v[128:129], v[108:109], v[112:113]
    v_pk_mul_f32 v[130:131], v[116:117], v[120:121]
    v_pk_fma_f32 v[124:125], v[80:81], v[108:109], v[124:125]
    v_pk_fma_f32 v[126:127], v[88:89], v[116:117], v[126:127]
    v_pk_mul_f32 v[124:125], v[124:125], v[130:131]
    v_pk_mul_f32 v[126:127], v[126:127], v[128:129]
    buffer_load_dwordx4 v[24:25], s[20:23], 0 idxen offen offset:3072 lds
    v_pk_mul_f32 v[128:129], v[128:129], v[130:131]
    s_setprio 1
    s_waitcnt lgkmcnt(0)
    v_mfma_f32_32x32x16_bf16 v[60:75], v[160:163], v[164:167], v[60:75]
    v_exp_f32 v108, v92
    v_exp_f32 v109, v93
    v_exp_f32 v110, v94
    v_exp_f32 v111, v95
    v_mfma_f32_32x32x16_bf16 v[76:91], v[26:29], v[30:33], 0
    v_exp_f32 v112, v96
    v_exp_f32 v113, v97
    v_exp_f32 v114, v98
    v_exp_f32 v115, v99
    v_mfma_f32_32x32x16_bf16 v[76:91], v[132:135], v[148:151], v[76:91]
    v_max3_f32 v228, v228, v128, v129
    v_exp_f32 v116, v100
    v_exp_f32 v117, v101
    v_exp_f32 v118, v102
    v_exp_f32 v119, v103
    v_mfma_f32_32x32x16_bf16 v[76:91], v[136:139], v[152:155], v[76:91]
    v_exp_f32 v120, v104
    v_exp_f32 v121, v105
    v_exp_f32 v122, v106
    v_exp_f32 v123, v107
    v_rcp_f32 v128, v128
    v_rcp_f32 v129, v129
    s_setprio 3
    ds_read_b128 v[140:143], v16 offset:0
    v_pk_add_f32 v[110:111], v[110:111], 1.0 op_sel_hi:[1,0]
    v_pk_add_f32 v[114:115], v[114:115], 1.0 op_sel_hi:[1,0]
    ds_read_b128 v[144:147], v17 offset:0
    v_pk_add_f32 v[118:119], v[118:119], 1.0 op_sel_hi:[1,0]
    v_pk_add_f32 v[122:123], v[122:123], 1.0 op_sel_hi:[1,0]
    ds_read_b64_tr_b16 v[36:37], v10 offset:64
    v_pk_mul_f32 v[124:125], v[124:125], v[128:129]
    v_pk_mul_f32 v[126:127], v[126:127], v[128:129]
    ds_read_b64_tr_b16 v[164:165], v13
    v_pk_fma_f32 v[92:93], v[92:93], v[110:111], v[94:95]
    v_pk_fma_f32 v[96:97], v[96:97], v[114:115], v[98:99]
    ds_read_u8 v9, v6 offset:32
    v_pk_fma_f32 v[100:101], v[100:101], v[118:119], v[102:103]
    v_pk_fma_f32 v[104:105], v[104:105], v[122:123], v[106:107]
    ds_read_u16 v18, v4 offset:384
    v_cvt_pk_bf16_f32 v156, v124, v125
    v_cvt_pk_bf16_f32 v157, v126, v127
    ds_read_u16 v20, v4 offset:388
    v_pk_fma_f32 v[92:93], v[94:95], v[108:109], v[92:93]
    v_pk_fma_f32 v[96:97], v[98:99], v[112:113], v[96:97]
    ds_read_u16 v22, v4 offset:400
    v_pk_fma_f32 v[100:101], v[102:103], v[116:117], v[100:101]
    v_pk_fma_f32 v[104:105], v[106:107], v[120:121], v[104:105]
    ds_read_u16 v24, v4 offset:404
    v_pk_fma_f32 v[108:109], v[108:109], v[110:111], v[110:111]
    v_pk_fma_f32 v[112:113], v[112:113], v[114:115], v[114:115]
    v_pk_fma_f32 v[116:117], v[116:117], v[118:119], v[118:119]
    v_pk_fma_f32 v[120:121], v[120:121], v[122:123], v[122:123]
    v_pk_mul_f32 v[124:125], v[92:93], v[112:113]
    v_pk_mul_f32 v[126:127], v[100:101], v[120:121]
    v_pk_mul_f32 v[128:129], v[108:109], v[112:113]
    v_pk_mul_f32 v[130:131], v[116:117], v[120:121]
    v_pk_fma_f32 v[124:125], v[96:97], v[108:109], v[124:125]
    v_pk_fma_f32 v[126:127], v[104:105], v[116:117], v[126:127]
    v_pk_mul_f32 v[124:125], v[124:125], v[130:131]
    v_pk_mul_f32 v[126:127], v[126:127], v[128:129]
    v_add_u32 v4, 192, v4
    v_add_u32 v5, v8, v5
    v_add_u32 v6, 24, v6
    s_sub_u32 s54, s54, 1
    v_pk_mul_f32 v[128:129], v[128:129], v[130:131]
    s_cbranch_scc1 k2_drain
    s_setprio 0
    s_waitcnt lgkmcnt(0)
    v_mfma_f32_32x32x16_bf16 v[92:107], v[26:29], v[34:37], 0
    v_exp_f32 v108, v76
    v_exp_f32 v109, v77
    v_exp_f32 v110, v78
    v_exp_f32 v111, v79
    v_exp_f32 v112, v80
    v_exp_f32 v113, v81
    v_mfma_f32_32x32x16_bf16 v[92:107], v[140:143], v[148:151], v[92:107]
    v_max3_f32 v228, v228, v128, v129
    v_exp_f32 v114, v82
    v_exp_f32 v115, v83
    v_exp_f32 v116, v84
    v_exp_f32 v117, v85
    v_exp_f32 v118, v86
    v_exp_f32 v119, v87
    v_mfma_f32_32x32x16_bf16 v[92:107], v[144:147], v[152:155], v[92:107]
    v_mad_u32_u24 v10, v9, s68, v7
    v_add_u32 v12, s69, v10
    v_exp_f32 v120, v88
    v_exp_f32 v121, v89
    v_exp_f32 v122, v90
    v_exp_f32 v123, v91
    v_rcp_f32 v128, v128
    v_rcp_f32 v129, v129
    s_setprio 2
    s_waitcnt vmcnt(4)
    v_pk_add_f32 v[110:111], v[110:111], 1.0 op_sel_hi:[1,0]
    ds_read_b128 v[132:135], v14 offset:4096
    v_pk_add_f32 v[114:115], v[114:115], 1.0 op_sel_hi:[1,0]
    ds_read_b128 v[136:139], v15 offset:4096
    v_pk_add_f32 v[118:119], v[118:119], 1.0 op_sel_hi:[1,0]
    ds_read_b64_tr_b16 v[32:33], v10
    v_pk_add_f32 v[122:123], v[122:123], 1.0 op_sel_hi:[1,0]
    ds_read_b128 v[26:29], v5 offset:512
    v_pk_mul_f32 v[124:125], v[124:125], v[128:129]
    s_add_u32 m0, s53, 0
    v_pk_mul_f32 v[126:127], v[126:127], v[128:129]
    v_pk_fma_f32 v[76:77], v[76:77], v[110:111], v[78:79]
    buffer_load_dwordx4 v[18:19], s[20:23], 0 idxen offen offset:0 lds
    v_pk_fma_f32 v[80:81], v[80:81], v[114:115], v[82:83]
    v_pk_fma_f32 v[84:85], v[84:85], v[118:119], v[86:87]
    v_pk_fma_f32 v[88:89], v[88:89], v[122:123], v[90:91]
    v_cvt_pk_bf16_f32 v160, v124, v125
    v_cvt_pk_bf16_f32 v161, v126, v127
    v_pk_fma_f32 v[76:77], v[78:79], v[108:109], v[76:77]
    v_pk_fma_f32 v[80:81], v[82:83], v[112:113], v[80:81]
    buffer_load_dwordx4 v[20:21], s[20:23], 0 idxen offen offset:1024 lds
    v_pk_fma_f32 v[84:85], v[86:87], v[116:117], v[84:85]
    v_pk_fma_f32 v[88:89], v[90:91], v[120:121], v[88:89]
    v_pk_fma_f32 v[108:109], v[108:109], v[110:111], v[110:111]
    v_pk_fma_f32 v[112:113], v[112:113], v[114:115], v[114:115]
    v_pk_fma_f32 v[116:117], v[116:117], v[118:119], v[118:119]
    v_pk_fma_f32 v[120:121], v[120:121], v[122:123], v[122:123]
    v_pk_mul_f32 v[124:125], v[76:77], v[112:113]
    buffer_load_dwordx4 v[22:23], s[20:23], 0 idxen offen offset:2048 lds
    v_pk_mul_f32 v[126:127], v[84:85], v[120:121]
    v_pk_mul_f32 v[128:129], v[108:109], v[112:113]
    v_pk_mul_f32 v[130:131], v[116:117], v[120:121]
    v_pk_fma_f32 v[124:125], v[80:81], v[108:109], v[124:125]
    v_pk_fma_f32 v[126:127], v[88:89], v[116:117], v[126:127]
    v_pk_mul_f32 v[124:125], v[124:125], v[130:131]
    v_pk_mul_f32 v[126:127], v[126:127], v[128:129]
    buffer_load_dwordx4 v[24:25], s[20:23], 0 idxen offen offset:3072 lds
    v_pk_mul_f32 v[128:129], v[128:129], v[130:131]
    s_setprio 0
    s_waitcnt lgkmcnt(0)
    v_mfma_f32_32x32x16_bf16 v[76:91], v[26:29], v[30:33], 0
    v_exp_f32 v108, v92
    v_exp_f32 v109, v93
    v_exp_f32 v110, v94
    v_exp_f32 v111, v95
    v_exp_f32 v112, v96
    v_exp_f32 v113, v97
    v_mfma_f32_32x32x16_bf16 v[76:91], v[132:135], v[148:151], v[76:91]
    v_max3_f32 v228, v228, v128, v129
    v_exp_f32 v114, v98
    v_exp_f32 v115, v99
    v_exp_f32 v116, v100
    v_exp_f32 v117, v101
    v_exp_f32 v118, v102
    v_exp_f32 v119, v103
    v_mfma_f32_32x32x16_bf16 v[76:91], v[136:139], v[152:155], v[76:91]
    v_exp_f32 v120, v104
    v_exp_f32 v121, v105
    v_exp_f32 v122, v106
    v_exp_f32 v123, v107
    v_rcp_f32 v128, v128
    v_rcp_f32 v129, v129
    s_setprio 2
    ds_read_b128 v[140:143], v16 offset:4096
    v_pk_add_f32 v[110:111], v[110:111], 1.0 op_sel_hi:[1,0]
    v_pk_add_f32 v[114:115], v[114:115], 1.0 op_sel_hi:[1,0]
    ds_read_b128 v[144:147], v17 offset:4096
    v_pk_add_f32 v[118:119], v[118:119], 1.0 op_sel_hi:[1,0]
    v_pk_add_f32 v[122:123], v[122:123], 1.0 op_sel_hi:[1,0]
    ds_read_b64_tr_b16 v[36:37], v10 offset:64
    v_pk_mul_f32 v[124:125], v[124:125], v[128:129]
    v_pk_mul_f32 v[126:127], v[126:127], v[128:129]
    ds_read_b64_tr_b16 v[166:167], v11
    v_pk_fma_f32 v[92:93], v[92:93], v[110:111], v[94:95]
    v_pk_fma_f32 v[96:97], v[96:97], v[114:115], v[98:99]
    ds_read_u8 v9, v6 offset:16
    v_pk_fma_f32 v[100:101], v[100:101], v[118:119], v[102:103]
    v_pk_fma_f32 v[104:105], v[104:105], v[122:123], v[106:107]
    ds_read_u16 v18, v4 offset:256
    v_cvt_pk_bf16_f32 v158, v124, v125
    v_cvt_pk_bf16_f32 v159, v126, v127
    ds_read_u16 v20, v4 offset:260
    v_pk_fma_f32 v[92:93], v[94:95], v[108:109], v[92:93]
    v_pk_fma_f32 v[96:97], v[98:99], v[112:113], v[96:97]
    ds_read_u16 v22, v4 offset:272
    v_pk_fma_f32 v[100:101], v[102:103], v[116:117], v[100:101]
    v_pk_fma_f32 v[104:105], v[106:107], v[120:121], v[104:105]
    ds_read_u16 v24, v4 offset:276
    v_pk_fma_f32 v[108:109], v[108:109], v[110:111], v[110:111]
    v_pk_fma_f32 v[112:113], v[112:113], v[114:115], v[114:115]
    v_pk_fma_f32 v[116:117], v[116:117], v[118:119], v[118:119]
    v_pk_fma_f32 v[120:121], v[120:121], v[122:123], v[122:123]
    v_pk_mul_f32 v[124:125], v[92:93], v[112:113]
    v_pk_mul_f32 v[126:127], v[100:101], v[120:121]
    v_pk_mul_f32 v[128:129], v[108:109], v[112:113]
    v_pk_mul_f32 v[130:131], v[116:117], v[120:121]
    v_pk_fma_f32 v[124:125], v[96:97], v[108:109], v[124:125]
    v_pk_fma_f32 v[126:127], v[104:105], v[116:117], v[126:127]
    v_pk_mul_f32 v[124:125], v[124:125], v[130:131]
    v_pk_mul_f32 v[126:127], v[126:127], v[128:129]
    s_sub_u32 s54, s54, 1
    v_pk_mul_f32 v[128:129], v[128:129], v[130:131]
    s_cbranch_scc1 k2_drain1
    s_setprio 0
    s_waitcnt lgkmcnt(0)
    v_mfma_f32_32x32x16_bf16 v[44:59], v[156:159], v[164:167], v[44:59]
    v_exp_f32 v108, v76
    v_exp_f32 v109, v77
    v_exp_f32 v110, v78
    v_exp_f32 v111, v79
    v_mfma_f32_32x32x16_bf16 v[92:107], v[26:29], v[34:37], 0
    v_exp_f32 v112, v80
    v_exp_f32 v113, v81
    v_exp_f32 v114, v82
    v_exp_f32 v115, v83
    v_mfma_f32_32x32x16_bf16 v[92:107], v[140:143], v[148:151], v[92:107]
    v_max3_f32 v228, v228, v128, v129
    v_exp_f32 v116, v84
    v_exp_f32 v117, v85
    v_exp_f32 v118, v86
    v_exp_f32 v119, v87
    v_mfma_f32_32x32x16_bf16 v[92:107], v[144:147], v[152:155], v[92:107]
    v_mad_u32_u24 v10, v9, s68, v7
    v_add_u32 v13, s69, v10
    v_exp_f32 v120, v88
    v_exp_f32 v121, v89
    v_exp_f32 v122, v90
    v_exp_f32 v123, v91
    v_rcp_f32 v128, v128
    v_rcp_f32 v129, v129
    s_setprio 2
    s_waitcnt vmcnt(4)
    v_pk_add_f32 v[110:111], v[110:111], 1.0 op_sel_hi:[1,0]
    ds_read_b128 v[132:135], v14 offset:8192
    v_pk_add_f32 v[114:115], v[114:115], 1.0 op_sel_hi:[1,0]
    ds_read_b128 v[136:139], v15 offset:8192
    v_pk_add_f32 v[118:119], v[118:119], 1.0 op_sel_hi:[1,0]
    ds_read_b64_tr_b16 v[32:33], v10
    v_pk_add_f32 v[122:123], v[122:123], 1.0 op_sel_hi:[1,0]
    ds_read_b128 v[26:29], v5 offset:1024
    v_pk_mul_f32 v[124:125], v[124:125], v[128:129]
    s_add_u32 m0, s53, 4096
    v_pk_mul_f32 v[126:127], v[126:127], v[128:129]
    v_pk_fma_f32 v[76:77], v[76:77], v[110:111], v[78:79]
    buffer_load_dwordx4 v[18:19], s[20:23], 0 idxen offen offset:0 lds
    v_pk_fma_f32 v[80:81], v[80:81], v[114:115], v[82:83]
    v_pk_fma_f32 v[84:85], v[84:85], v[118:119], v[86:87]
    v_pk_fma_f32 v[88:89], v[88:89], v[122:123], v[90:91]
    v_cvt_pk_bf16_f32 v162, v124, v125
    v_cvt_pk_bf16_f32 v163, v126, v127
    v_pk_fma_f32 v[76:77], v[78:79], v[108:109], v[76:77]
    v_pk_fma_f32 v[80:81], v[82:83], v[112:113], v[80:81]
    buffer_load_dwordx4 v[20:21], s[20:23], 0 idxen offen offset:1024 lds
    v_pk_fma_f32 v[84:85], v[86:87], v[116:117], v[84:85]
    v_pk_fma_f32 v[88:89], v[90:91], v[120:121], v[88:89]
    v_pk_fma_f32 v[108:109], v[108:109], v[110:111], v[110:111]
    v_pk_fma_f32 v[112:113], v[112:113], v[114:115], v[114:115]
    v_pk_fma_f32 v[116:117], v[116:117], v[118:119], v[118:119]
    v_pk_fma_f32 v[120:121], v[120:121], v[122:123], v[122:123]
    v_pk_mul_f32 v[124:125], v[76:77], v[112:113]
    buffer_load_dwordx4 v[22:23], s[20:23], 0 idxen offen offset:2048 lds
    v_pk_mul_f32 v[126:127], v[84:85], v[120:121]
    v_pk_mul_f32 v[128:129], v[108:109], v[112:113]
    v_pk_mul_f32 v[130:131], v[116:117], v[120:121]
    v_pk_fma_f32 v[124:125], v[80:81], v[108:109], v[124:125]
    v_pk_fma_f32 v[126:127], v[88:89], v[116:117], v[126:127]
    v_pk_mul_f32 v[124:125], v[124:125], v[130:131]
    v_pk_mul_f32 v[126:127], v[126:127], v[128:129]
    buffer_load_dwordx4 v[24:25], s[20:23], 0 idxen offen offset:3072 lds
    v_pk_mul_f32 v[128:129], v[128:129], v[130:131]
    s_setprio 0
    s_waitcnt lgkmcnt(0)
    v_mfma_f32_32x32x16_bf16 v[60:75], v[160:163], v[164:167], v[60:75]
    v_exp_f32 v108, v92
    v_exp_f32 v109, v93
    v_exp_f32 v110, v94
    v_exp_f32 v111, v95
    v_mfma_f32_32x32x16_bf16 v[76:91], v[26:29], v[30:33], 0
    v_exp_f32 v112, v96
    v_exp_f32 v113, v97
    v_exp_f32 v114, v98
    v_exp_f32 v115, v99
    v_mfma_f32_32x32x16_bf16 v[76:91], v[132:135], v[148:151], v[76:91]
    v_max3_f32 v228, v228, v128, v129
    v_exp_f32 v116, v100
    v_exp_f32 v117, v101
    v_exp_f32 v118, v102
    v_exp_f32 v119, v103
    v_mfma_f32_32x32x16_bf16 v[76:91], v[136:139], v[152:155], v[76:91]
    v_exp_f32 v120, v104
    v_exp_f32 v121, v105
    v_exp_f32 v122, v106
    v_exp_f32 v123, v107
    v_rcp_f32 v128, v128
    v_rcp_f32 v129, v129
    s_setprio 2
    ds_read_b128 v[140:143], v16 offset:8192
    v_pk_add_f32 v[110:111], v[110:111], 1.0 op_sel_hi:[1,0]
    v_pk_add_f32 v[114:115], v[114:115], 1.0 op_sel_hi:[1,0]
    ds_read_b128 v[144:147], v17 offset:8192
    v_pk_add_f32 v[118:119], v[118:119], 1.0 op_sel_hi:[1,0]
    v_pk_add_f32 v[122:123], v[122:123], 1.0 op_sel_hi:[1,0]
    ds_read_b64_tr_b16 v[36:37], v10 offset:64
    v_pk_mul_f32 v[124:125], v[124:125], v[128:129]
    v_pk_mul_f32 v[126:127], v[126:127], v[128:129]
    ds_read_b64_tr_b16 v[164:165], v12
    v_pk_fma_f32 v[92:93], v[92:93], v[110:111], v[94:95]
    v_pk_fma_f32 v[96:97], v[96:97], v[114:115], v[98:99]
    ds_read_u8 v9, v6 offset:24
    v_pk_fma_f32 v[100:101], v[100:101], v[118:119], v[102:103]
    v_pk_fma_f32 v[104:105], v[104:105], v[122:123], v[106:107]
    ds_read_u16 v18, v4 offset:320
    v_cvt_pk_bf16_f32 v156, v124, v125
    v_cvt_pk_bf16_f32 v157, v126, v127
    ds_read_u16 v20, v4 offset:324
    v_pk_fma_f32 v[92:93], v[94:95], v[108:109], v[92:93]
    v_pk_fma_f32 v[96:97], v[98:99], v[112:113], v[96:97]
    ds_read_u16 v22, v4 offset:336
    v_pk_fma_f32 v[100:101], v[102:103], v[116:117], v[100:101]
    v_pk_fma_f32 v[104:105], v[106:107], v[120:121], v[104:105]
    ds_read_u16 v24, v4 offset:340
    v_pk_fma_f32 v[108:109], v[108:109], v[110:111], v[110:111]
    v_pk_fma_f32 v[112:113], v[112:113], v[114:115], v[114:115]
    v_pk_fma_f32 v[116:117], v[116:117], v[118:119], v[118:119]
    v_pk_fma_f32 v[120:121], v[120:121], v[122:123], v[122:123]
    v_pk_mul_f32 v[124:125], v[92:93], v[112:113]
    v_pk_mul_f32 v[126:127], v[100:101], v[120:121]
    v_pk_mul_f32 v[128:129], v[108:109], v[112:113]
    v_pk_mul_f32 v[130:131], v[116:117], v[120:121]
    v_pk_fma_f32 v[124:125], v[96:97], v[108:109], v[124:125]
    v_pk_fma_f32 v[126:127], v[104:105], v[116:117], v[126:127]
    v_pk_mul_f32 v[124:125], v[124:125], v[130:131]
    v_pk_mul_f32 v[126:127], v[126:127], v[128:129]
    s_sub_u32 s54, s54, 1
    v_pk_mul_f32 v[128:129], v[128:129], v[130:131]
    s_cbranch_scc1 k2_drain
    s_setprio 1
    s_waitcnt lgkmcnt(0)
    v_mfma_f32_32x32x16_bf16 v[92:107], v[26:29], v[34:37], 0
    v_exp_f32 v108, v76
    v_exp_f32 v109, v77
    v_exp_f32 v110, v78
    v_exp_f32 v111, v79
    v_exp_f32 v112, v80
    v_exp_f32 v113, v81
    v_mfma_f32_32x32x16_bf16 v[92:107], v[140:143], v[148:151], v[92:107]
    v_max3_f32 v228, v228, v128, v129
    v_exp_f32 v114, v82
    v_exp_f32 v115, v83
    v_exp_f32 v116, v84
    v_exp_f32 v117, v85
    v_exp_f32 v118, v86
    v_exp_f32 v119, v87
    v_mfma_f32_32x32x16_bf16 v[92:107], v[144:147], v[152:155], v[92:107]
    v_mad_u32_u24 v10, v9, s68, v7
    v_add_u32 v11, s69, v10
    v_exp_f32 v120, v88
    v_exp_f32 v121, v89
    v_exp_f32 v122, v90
    v_exp_f32 v123, v91
    v_rcp_f32 v128, v128
    v_rcp_f32 v129, v129
    s_setprio 3
    s_waitcnt vmcnt(4)
    v_pk_add_f32 v[110:111], v[110:111], 1.0 op_sel_hi:[1,0]
    ds_read_b128 v[132:135], v14 offset:0
    v_pk_add_f32 v[114:115], v[114:115], 1.0 op_sel_hi:[1,0]
    ds_read_b128 v[136:139], v15 offset:0
    v_pk_add_f32 v[118:119], v[118:119], 1.0 op_sel_hi:[1,0]
    ds_read_b64_tr_b16 v[32:33], v10
    v_pk_add_f32 v[122:123], v[122:123], 1.0 op_sel_hi:[1,0]
    ds_read_b128 v[26:29], v5 offset:1536
    v_pk_mul_f32 v[124:125], v[124:125], v[128:129]
    s_add_u32 m0, s53, 8192
    v_pk_mul_f32 v[126:127], v[126:127], v[128:129]
    v_pk_fma_f32 v[76:77], v[76:77], v[110:111], v[78:79]
    buffer_load_dwordx4 v[18:19], s[20:23], 0 idxen offen offset:0 lds
    v_pk_fma_f32 v[80:81], v[80:81], v[114:115], v[82:83]
    v_pk_fma_f32 v[84:85], v[84:85], v[118:119], v[86:87]
    v_pk_fma_f32 v[88:89], v[88:89], v[122:123], v[90:91]
    v_cvt_pk_bf16_f32 v160, v124, v125
    v_cvt_pk_bf16_f32 v161, v126, v127
    v_pk_fma_f32 v[76:77], v[78:79], v[108:109], v[76:77]
    v_pk_fma_f32 v[80:81], v[82:83], v[112:113], v[80:81]
    buffer_load_dwordx4 v[20:21], s[20:23], 0 idxen offen offset:1024 lds
    v_pk_fma_f32 v[84:85], v[86:87], v[116:117], v[84:85]
    v_pk_fma_f32 v[88:89], v[90:91], v[120:121], v[88:89]
    v_pk_fma_f32 v[108:109], v[108:109], v[110:111], v[110:111]
    v_pk_fma_f32 v[112:113], v[112:113], v[114:115], v[114:115]
    v_pk_fma_f32 v[116:117], v[116:117], v[118:119], v[118:119]
    v_pk_fma_f32 v[120:121], v[120:121], v[122:123], v[122:123]
    v_pk_mul_f32 v[124:125], v[76:77], v[112:113]
    buffer_load_dwordx4 v[22:23], s[20:23], 0 idxen offen offset:2048 lds
    v_pk_mul_f32 v[126:127], v[84:85], v[120:121]
    v_pk_mul_f32 v[128:129], v[108:109], v[112:113]
    v_pk_mul_f32 v[130:131], v[116:117], v[120:121]
    v_pk_fma_f32 v[124:125], v[80:81], v[108:109], v[124:125]
    v_pk_fma_f32 v[126:127], v[88:89], v[116:117], v[126:127]
    v_pk_mul_f32 v[124:125], v[124:125], v[130:131]
    v_pk_mul_f32 v[126:127], v[126:127], v[128:129]
    buffer_load_dwordx4 v[24:25], s[20:23], 0 idxen offen offset:3072 lds
    v_pk_mul_f32 v[128:129], v[128:129], v[130:131]
    s_setprio 1
    s_waitcnt lgkmcnt(0)
    v_mfma_f32_32x32x16_bf16 v[76:91], v[26:29], v[30:33], 0
    v_exp_f32 v108, v92
    v_exp_f32 v109, v93
    v_exp_f32 v110, v94
    v_exp_f32 v111, v95
    v_exp_f32 v112, v96
    v_exp_f32 v113, v97
    v_mfma_f32_32x32x16_bf16 v[76:91], v[132:135], v[148:151], v[76:91]
    v_max3_f32 v228, v228, v128, v129
    v_exp_f32 v114, v98
    v_exp_f32 v115, v99
    v_exp_f32 v116, v100
    v_exp_f32 v117, v101
    v_exp_f32 v118, v102
    v_exp_f32 v119, v103
    v_mfma_f32_32x32x16_bf16 v[76:91], v[136:139], v[152:155], v[76:91]
    v_exp_f32 v120, v104
    v_exp_f32 v121, v105
    v_exp_f32 v122, v106
    v_exp_f32 v123, v107
    v_rcp_f32 v128, v128
    v_rcp_f32 v129, v129
    s_setprio 3
    ds_read_b128 v[140:143], v16 offset:0
    v_pk_add_f32 v[110:111], v[110:111], 1.0 op_sel_hi:[1,0]
    v_pk_add_f32 v[114:115], v[114:115], 1.0 op_sel_hi:[1,0]
    ds_read_b128 v[144:147], v17 offset:0
    v_pk_add_f32 v[118:119], v[118:119], 1.0 op_sel_hi:[1,0]
    v_pk_add_f32 v[122:123], v[122:123], 1.0 op_sel_hi:[1,0]
    ds_read_b64_tr_b16 v[36:37], v10 offset:64
    v_pk_mul_f32 v[124:125], v[124:125], v[128:129]
    v_pk_mul_f32 v[126:127], v[126:127], v[128:129]
    ds_read_b64_tr_b16 v[166:167], v13
    v_pk_fma_f32 v[92:93], v[92:93], v[110:111], v[94:95]
    v_pk_fma_f32 v[96:97], v[96:97], v[114:115], v[98:99]
    ds_read_u8 v9, v6 offset:32
    v_pk_fma_f32 v[100:101], v[100:101], v[118:119], v[102:103]
    v_pk_fma_f32 v[104:105], v[104:105], v[122:123], v[106:107]
    ds_read_u16 v18, v4 offset:384
    v_cvt_pk_bf16_f32 v158, v124, v125
    v_cvt_pk_bf16_f32 v159, v126, v127
    ds_read_u16 v20, v4 offset:388
    v_pk_fma_f32 v[92:93], v[94:95], v[108:109], v[92:93]
    v_pk_fma_f32 v[96:97], v[98:99], v[112:113], v[96:97]
    ds_read_u16 v22, v4 offset:400
    v_pk_fma_f32 v[100:101], v[102:103], v[116:117], v[100:101]
    v_pk_fma_f32 v[104:105], v[106:107], v[120:121], v[104:105]
    ds_read_u16 v24, v4 offset:404
    v_pk_fma_f32 v[108:109], v[108:109], v[110:111], v[110:111]
    v_pk_fma_f32 v[112:113], v[112:113], v[114:115], v[114:115]
    v_pk_fma_f32 v[116:117], v[116:117], v[118:119], v[118:119]
    v_pk_fma_f32 v[120:121], v[120:121], v[122:123], v[122:123]
    v_pk_mul_f32 v[124:125], v[92:93], v[112:113]
    v_pk_mul_f32 v[126:127], v[100:101], v[120:121]
    v_pk_mul_f32 v[128:129], v[108:109], v[112:113]
    v_pk_mul_f32 v[130:131], v[116:117], v[120:121]
    v_pk_fma_f32 v[124:125], v[96:97], v[108:109], v[124:125]
    v_pk_fma_f32 v[126:127], v[104:105], v[116:117], v[126:127]
    v_pk_mul_f32 v[124:125], v[124:125], v[130:131]
    v_pk_mul_f32 v[126:127], v[126:127], v[128:129]
    v_add_u32 v4, 192, v4
    v_add_u32 v5, v8, v5
    v_add_u32 v6, 24, v6
    s_sub_u32 s54, s54, 1
    v_pk_mul_f32 v[128:129], v[128:129], v[130:131]
    s_cbranch_scc1 k2_drain1
    s_setprio 0
    s_waitcnt lgkmcnt(0)
    v_mfma_f32_32x32x16_bf16 v[44:59], v[156:159], v[164:167], v[44:59]
    v_exp_f32 v108, v76
    v_exp_f32 v109, v77
    v_exp_f32 v110, v78
    v_exp_f32 v111, v79
    v_mfma_f32_32x32x16_bf16 v[92:107], v[26:29], v[34:37], 0
    v_exp_f32 v112, v80
    v_exp_f32 v113, v81
    v_exp_f32 v114, v82
    v_exp_f32 v115, v83
    v_mfma_f32_32x32x16_bf16 v[92:107], v[140:143], v[148:151], v[92:107]
    v_max3_f32 v228, v228, v128, v129
    v_exp_f32 v116, v84
    v_exp_f32 v117, v85
    v_exp_f32 v118, v86
    v_exp_f32 v119, v87
    v_mfma_f32_32x32x16_bf16 v[92:107], v[144:147], v[152:155], v[92:107]
    v_mad_u32_u24 v10, v9, s68, v7
    v_add_u32 v12, s69, v10
    v_exp_f32 v120, v88
    v_exp_f32 v121, v89
    v_exp_f32 v122, v90
    v_exp_f32 v123, v91
    v_rcp_f32 v128, v128
    v_rcp_f32 v129, v129
    s_setprio 2
    s_waitcnt vmcnt(4)
    v_pk_add_f32 v[110:111], v[110:111], 1.0 op_sel_hi:[1,0]
    ds_read_b128 v[132:135], v14 offset:4096
    v_pk_add_f32 v[114:115], v[114:115], 1.0 op_sel_hi:[1,0]
    ds_read_b128 v[136:139], v15 offset:4096
    v_pk_add_f32 v[118:119], v[118:119], 1.0 op_sel_hi:[1,0]
    ds_read_b64_tr_b16 v[32:33], v10
    v_pk_add_f32 v[122:123], v[122:123], 1.0 op_sel_hi:[1,0]
    ds_read_b128 v[26:29], v5 offset:512
    v_pk_mul_f32 v[124:125], v[124:125], v[128:129]
    s_add_u32 m0, s53, 0
    v_pk_mul_f32 v[126:127], v[126:127], v[128:129]
    v_pk_fma_f32 v[76:77], v[76:77], v[110:111], v[78:79]
    buffer_load_dwordx4 v[18:19], s[20:23], 0 idxen offen offset:0 lds
    v_pk_fma_f32 v[80:81], v[80:81], v[114:115], v[82:83]
    v_pk_fma_f32 v[84:85], v[84:85], v[118:119], v[86:87]
    v_pk_fma_f32 v[88:89], v[88:89], v[122:123], v[90:91]
    v_cvt_pk_bf16_f32 v162, v124, v125
    v_cvt_pk_bf16_f32 v163, v126, v127
    v_pk_fma_f32 v[76:77], v[78:79], v[108:109], v[76:77]
    v_pk_fma_f32 v[80:81], v[82:83], v[112:113], v[80:81]
    buffer_load_dwordx4 v[20:21], s[20:23], 0 idxen offen offset:1024 lds
    v_pk_fma_f32 v[84:85], v[86:87], v[116:117], v[84:85]
    v_pk_fma_f32 v[88:89], v[90:91], v[120:121], v[88:89]
    v_pk_fma_f32 v[108:109], v[108:109], v[110:111], v[110:111]
    v_pk_fma_f32 v[112:113], v[112:113], v[114:115], v[114:115]
    v_pk_fma_f32 v[116:117], v[116:117], v[118:119], v[118:119]
    v_pk_fma_f32 v[120:121], v[120:121], v[122:123], v[122:123]
    v_pk_mul_f32 v[124:125], v[76:77], v[112:113]
    buffer_load_dwordx4 v[22:23], s[20:23], 0 idxen offen offset:2048 lds
    v_pk_mul_f32 v[126:127], v[84:85], v[120:121]
    v_pk_mul_f32 v[128:129], v[108:109], v[112:113]
    v_pk_mul_f32 v[130:131], v[116:117], v[120:121]
    v_pk_fma_f32 v[124:125], v[80:81], v[108:109], v[124:125]
    v_pk_fma_f32 v[126:127], v[88:89], v[116:117], v[126:127]
    v_pk_mul_f32 v[124:125], v[124:125], v[130:131]
    v_pk_mul_f32 v[126:127], v[126:127], v[128:129]
    buffer_load_dwordx4 v[24:25], s[20:23], 0 idxen offen offset:3072 lds
    v_pk_mul_f32 v[128:129], v[128:129], v[130:131]
    s_setprio 0
    s_waitcnt lgkmcnt(0)
    v_mfma_f32_32x32x16_bf16 v[60:75], v[160:163], v[164:167], v[60:75]
    v_exp_f32 v108, v92
    v_exp_f32 v109, v93
    v_exp_f32 v110, v94
    v_exp_f32 v111, v95
    v_mfma_f32_32x32x16_bf16 v[76:91], v[26:29], v[30:33], 0
    v_exp_f32 v112, v96
    v_exp_f32 v113, v97
    v_exp_f32 v114, v98
    v_exp_f32 v115, v99
    v_mfma_f32_32x32x16_bf16 v[76:91], v[132:135], v[148:151], v[76:91]
    v_max3_f32 v228, v228, v128, v129
    v_exp_f32 v116, v100
    v_exp_f32 v117, v101
    v_exp_f32 v118, v102
    v_exp_f32 v119, v103
    v_mfma_f32_32x32x16_bf16 v[76:91], v[136:139], v[152:155], v[76:91]
    v_exp_f32 v120, v104
    v_exp_f32 v121, v105
    v_exp_f32 v122, v106
    v_exp_f32 v123, v107
    v_rcp_f32 v128, v128
    v_rcp_f32 v129, v129
    s_setprio 2
    ds_read_b128 v[140:143], v16 offset:4096
    v_pk_add_f32 v[110:111], v[110:111], 1.0 op_sel_hi:[1,0]
    v_pk_add_f32 v[114:115], v[114:115], 1.0 op_sel_hi:[1,0]
    ds_read_b128 v[144:147], v17 offset:4096
    v_pk_add_f32 v[118:119], v[118:119], 1.0 op_sel_hi:[1,0]
    v_pk_add_f32 v[122:123], v[122:123], 1.0 op_sel_hi:[1,0]
    ds_read_b64_tr_b16 v[36:37], v10 offset:64
    v_pk_mul_f32 v[124:125], v[124:125], v[128:129]
    v_pk_mul_f32 v[126:127], v[126:127], v[128:129]
    ds_read_b64_tr_b16 v[164:165], v11
    v_pk_fma_f32 v[92:93], v[92:93], v[110:111], v[94:95]
    v_pk_fma_f32 v[96:97], v[96:97], v[114:115], v[98:99]
    ds_read_u8 v9, v6 offset:16
    v_pk_fma_f32 v[100:101], v[100:101], v[118:119], v[102:103]
    v_pk_fma_f32 v[104:105], v[104:105], v[122:123], v[106:107]
    ds_read_u16 v18, v4 offset:256
    v_cvt_pk_bf16_f32 v156, v124, v125
    v_cvt_pk_bf16_f32 v157, v126, v127
    ds_read_u16 v20, v4 offset:260
    v_pk_fma_f32 v[92:93], v[94:95], v[108:109], v[92:93]
    v_pk_fma_f32 v[96:97], v[98:99], v[112:113], v[96:97]
    ds_read_u16 v22, v4 offset:272
    v_pk_fma_f32 v[100:101], v[102:103], v[116:117], v[100:101]
    v_pk_fma_f32 v[104:105], v[106:107], v[120:121], v[104:105]
    ds_read_u16 v24, v4 offset:276
    v_pk_fma_f32 v[108:109], v[108:109], v[110:111], v[110:111]
    v_pk_fma_f32 v[112:113], v[112:113], v[114:115], v[114:115]
    v_pk_fma_f32 v[116:117], v[116:117], v[118:119], v[118:119]
    v_pk_fma_f32 v[120:121], v[120:121], v[122:123], v[122:123]
    v_pk_mul_f32 v[124:125], v[92:93], v[112:113]
    v_pk_mul_f32 v[126:127], v[100:101], v[120:121]
    v_pk_mul_f32 v[128:129], v[108:109], v[112:113]
    v_pk_mul_f32 v[130:131], v[116:117], v[120:121]
    v_pk_fma_f32 v[124:125], v[96:97], v[108:109], v[124:125]
    v_pk_fma_f32 v[126:127], v[104:105], v[116:117], v[126:127]
    v_pk_mul_f32 v[124:125], v[124:125], v[130:131]
    v_pk_mul_f32 v[126:127], v[126:127], v[128:129]
    s_sub_u32 s54, s54, 1
    v_pk_mul_f32 v[128:129], v[128:129], v[130:131]
    s_cbranch_scc0 k2_loop0
    s_branch k2_drain
k2_g1:
    s_setprio 1
    s_waitcnt lgkmcnt(0)
    s_cmp_lg_u32 s38, 0
    s_cbranch_scc1 kf_f1A_a
    v_mfma_f32_32x32x8_bf16 v[44:59], v[156:157], v[164:165], 0
kf_f1A_a:
    v_exp_f32 v108, v76
    v_exp_f32 v109, v77
    v_exp_f32 v110, v78
    v_exp_f32 v111, v79
    v_mfma_f32_32x32x16_bf16 v[92:107], v[26:29], v[34:37], 0
    v_exp_f32 v112, v80
    v_exp_f32 v113, v81
    v_exp_f32 v114, v82
    v_exp_f32 v115, v83
    v_mfma_f32_32x32x16_bf16 v[92:107], v[140:143], v[148:151], v[92:107]
    v_max3_f32 v228, v228, v128, v129
    v_exp_f32 v116, v84
    v_exp_f32 v117, v85
    v_exp_f32 v118, v86
    v_exp_f32 v119, v87
    v_mfma_f32_32x32x16_bf16 v[92:107], v[144:147], v[152:155], v[92:107]
    v_mad_u32_u24 v10, v9, s68, v7
    v_add_u32 v12, s69, v10
    v_exp_f32 v120, v88
    v_exp_f32 v121, v89
    v_exp_f32 v122, v90
    v_exp_f32 v123, v91
    v_rcp_f32 v128, v128
    v_rcp_f32 v129, v129
    s_setprio 3
    s_waitcnt vmcnt(4)
    v_pk_add_f32 v[110:111], v[110:111], 1.0 op_sel_hi:[1,0]
    ds_read_b128 v[132:135], v14 offset:4096
    v_pk_add_f32 v[114:115], v[114:115], 1.0 op_sel_hi:[1,0]
    ds_read_b128 v[136:139], v15 offset:4096
    v_pk_add_f32 v[118:119], v[118:119], 1.0 op_sel_hi:[1,0]
    ds_read_b64_tr_b16 v[32:33], v10
    v_pk_add_f32 v[122:123], v[122:123], 1.0 op_sel_hi:[1,0]
    ds_read_b128 v[26:29], v5 offset:512
    v_pk_mul_f32 v[124:125], v[124:125], v[128:129]
    s_add_u32 m0, s53, 8192
    v_pk_mul_f32 v[126:127], v[126:127], v[128:129]
    buffer_load_dwordx4 v[184:185], s[20:23], 0 idxen offen offset:0 lds
    v_pk_fma_f32 v[76:77], v[76:77], v[110:111], v[78:79]
    v_pk_fma_f32 v[80:81], v[80:81], v[114:115], v[82:83]
    v_pk_fma_f32 v[84:85], v[84:85], v[118:119], v[86:87]
    buffer_load_dwordx4 v[186:187], s[20:23], 0 idxen offen offset:1024 lds
    v_pk_fma_f32 v[88:89], v[88:89], v[122:123], v[90:91]
    v_cvt_pk_bf16_f32 v162, v124, v125
    v_cvt_pk_bf16_f32 v163, v126, v127
    buffer_load_dwordx4 v[188:189], s[20:23], 0 idxen offen offset:2048 lds
    v_pk_fma_f32 v[76:77], v[78:79], v[108:109], v[76:77]
    v_pk_fma_f32 v[80:81], v[82:83], v[112:113], v[80:81]
    v_pk_fma_f32 v[84:85], v[86:87], v[116:117], v[84:85]
    buffer_load_dwordx4 v[190:191], s[20:23], 0 idxen offen offset:3072 lds
    v_pk_fma_f32 v[88:89], v[90:91], v[120:121], v[88:89]
    v_pk_fma_f32 v[108:109], v[108:109], v[110:111], v[110:111]
    s_mov_b32 m0, s53
    v_pk_fma_f32 v[112:113], v[112:113], v[114:115], v[114:115]
    buffer_load_dwordx4 v[18:19], s[20:23], 0 idxen offen offset:0 lds
    v_pk_fma_f32 v[116:117], v[116:117], v[118:119], v[118:119]
    v_pk_fma_f32 v[120:121], v[120:121], v[122:123], v[122:123]
    v_pk_mul_f32 v[124:125], v[76:77], v[112:113]
    buffer_load_dwordx4 v[20:21], s[20:23], 0 idxen offen offset:1024 lds
    v_pk_mul_f32 v[126:127], v[84:85], v[120:121]
    v_pk_mul_f32 v[128:129], v[108:109], v[112:113]
    v_pk_mul_f32 v[130:131], v[116:117], v[120:121]
    buffer_load_dwordx4 v[22:23], s[20:23], 0 idxen offen offset:2048 lds
    v_pk_fma_f32 v[124:125], v[80:81], v[108:109], v[124:125]
    v_pk_fma_f32 v[126:127], v[88:89], v[116:117], v[126:127]
    v_pk_mul_f32 v[124:125], v[124:125], v[130:131]
    buffer_load_dwordx4 v[24:25], s[20:23], 0 idxen offen offset:3072 lds
    v_pk_mul_f32 v[126:127], v[126:127], v[128:129]
    v_pk_mul_f32 v[128:129], v[128:129], v[130:131]
    s_setprio 1
    s_waitcnt lgkmcnt(0)
    s_cmp_lg_u32 s38, 0
    s_cbranch_scc1 kf_f1B_a
    v_mfma_f32_32x32x8_bf16 v[60:75], v[160:161], v[164:165], 0
kf_f1B_a:
    v_exp_f32 v108, v92
    v_exp_f32 v109, v93
    v_exp_f32 v110, v94
    v_exp_f32 v111, v95
    v_mfma_f32_32x32x16_bf16 v[76:91], v[26:29], v[30:33], 0
    v_exp_f32 v112, v96
    v_exp_f32 v113, v97
    v_exp_f32 v114, v98
    v_exp_f32 v115, v99
    v_mfma_f32_32x32x16_bf16 v[76:91], v[132:135], v[148:151], v[76:91]
    v_max3_f32 v228, v228, v128, v129
    v_exp_f32 v116, v100
    v_exp_f32 v117, v101
    v_exp_f32 v118, v102
    v_exp_f32 v119, v103
    v_mfma_f32_32x32x16_bf16 v[76:91], v[136:139], v[152:155], v[76:91]
    v_exp_f32 v120, v104
    v_exp_f32 v121, v105
    v_exp_f32 v122, v106
    v_exp_f32 v123, v107
    v_rcp_f32 v128, v128
    v_rcp_f32 v129, v129
    s_setprio 3
    ds_read_b128 v[140:143], v16 offset:4096
    v_pk_add_f32 v[110:111], v[110:111], 1.0 op_sel_hi:[1,0]
    v_pk_add_f32 v[114:115], v[114:115], 1.0 op_sel_hi:[1,0]
    ds_read_b128 v[144:147], v17 offset:4096
    v_pk_add_f32 v[118:119], v[118:119], 1.0 op_sel_hi:[1,0]
    v_pk_add_f32 v[122:123], v[122:123], 1.0 op_sel_hi:[1,0]
    ds_read_b64_tr_b16 v[36:37], v10 offset:64
    v_pk_mul_f32 v[124:125], v[124:125], v[128:129]
    v_pk_mul_f32 v[126:127], v[126:127], v[128:129]
    ds_read_b64_tr_b16 v[164:165], v11
    v_pk_fma_f32 v[92:93], v[92:93], v[110:111], v[94:95]
    v_pk_fma_f32 v[96:97], v[96:97], v[114:115], v[98:99]
    ds_read_u8 v9, v6 offset:16
    v_pk_fma_f32 v[100:101], v[100:101], v[118:119], v[102:103]
    v_pk_fma_f32 v[104:105], v[104:105], v[122:123], v[106:107]
    ds_read_u16 v18, v4 offset:256
    v_cvt_pk_bf16_f32 v156, v124, v125
    v_cvt_pk_bf16_f32 v157, v126, v127
    ds_read_u16 v20, v4 offset:260
    v_pk_fma_f32 v[92:93], v[94:95], v[108:109], v[92:93]
    v_pk_fma_f32 v[96:97], v[98:99], v[112:113], v[96:97]
    ds_read_u16 v22, v4 offset:272
    v_pk_fma_f32 v[100:101], v[102:103], v[116:117], v[100:101]
    v_pk_fma_f32 v[104:105], v[106:107], v[120:121], v[104:105]
    ds_read_u16 v24, v4 offset:276
    v_pk_fma_f32 v[108:109], v[108:109], v[110:111], v[110:111]
    v_pk_fma_f32 v[112:113], v[112:113], v[114:115], v[114:115]
    v_pk_fma_f32 v[116:117], v[116:117], v[118:119], v[118:119]
    v_pk_fma_f32 v[120:121], v[120:121], v[122:123], v[122:123]
    v_pk_mul_f32 v[124:125], v[92:93], v[112:113]
    v_pk_mul_f32 v[126:127], v[100:101], v[120:121]
    v_pk_mul_f32 v[128:129], v[108:109], v[112:113]
    v_pk_mul_f32 v[130:131], v[116:117], v[120:121]
    v_pk_fma_f32 v[124:125], v[96:97], v[108:109], v[124:125]
    v_pk_fma_f32 v[126:127], v[104:105], v[116:117], v[126:127]
    s_mov_b32 s38, 1
    v_pk_mul_f32 v[124:125], v[124:125], v[130:131]
    v_pk_mul_f32 v[126:127], v[126:127], v[128:129]
    s_sub_u32 s54, s54, 1
    v_pk_mul_f32 v[128:129], v[128:129], v[130:131]
    s_cbranch_scc1 k2_drain
k2_loop1:
    s_setprio 1
    s_waitcnt lgkmcnt(0)
    v_mfma_f32_32x32x16_bf16 v[92:107], v[26:29], v[34:37], 0
    v_exp_f32 v108, v76
    v_exp_f32 v109, v77
    v_exp_f32 v110, v78
    v_exp_f32 v111, v79
    v_exp_f32 v112, v80
    v_exp_f32 v113, v81
    v_mfma_f32_32x32x16_bf16 v[92:107], v[140:143], v[148:151], v[92:107]
    v_max3_f32 v228, v228, v128, v129
    v_exp_f32 v114, v82
    v_exp_f32 v115, v83
    v_exp_f32 v116, v84
    v_exp_f32 v117, v85
    v_exp_f32 v118, v86
    v_exp_f32 v119, v87
    v_mfma_f32_32x32x16_bf16 v[92:107], v[144:147], v[152:155], v[92:107]
    v_mad_u32_u24 v10, v9, s68, v7
    v_add_u32 v13, s69, v10
    v_exp_f32 v120, v88
    v_exp_f32 v121, v89
    v_exp_f32 v122, v90
    v_exp_f32 v123, v91
    v_rcp_f32 v128, v128
    v_rcp_f32 v129, v129
    s_setprio 3
    s_waitcnt vmcnt(4)
    v_pk_add_f32 v[110:111], v[110:111], 1.0 op_sel_hi:[1,0]
    ds_read_b128 v[132:135], v14 offset:8192
    v_pk_add_f32 v[114:115], v[114:115], 1.0 op_sel_hi:[1,0]
    ds_read_b128 v[136:139], v15 offset:8192
    v_pk_add_f32 v[118:119], v[118:119], 1.0 op_sel_hi:[1,0]
    ds_read_b64_tr_b16 v[32:33], v10
    v_pk_add_f32 v[122:123], v[122:123], 1.0 op_sel_hi:[1,0]
    ds_read_b128 v[26:29], v5 offset:1024
    v_pk_mul_f32 v[124:125], v[124:125], v[128:129]
    s_add_u32 m0, s53, 4096
    v_pk_mul_f32 v[126:127], v[126:127], v[128:129]
    v_pk_fma_f32 v[76:77], v[76:77], v[110:111], v[78:79]
    buffer_load_dwordx4 v[18:19], s[20:23], 0 idxen offen offset:0 lds
    v_pk_fma_f32 v[80:81], v[80:81], v[114:115], v[82:83]
    v_pk_fma_f32 v[84:85], v[84:85], v[118:119], v[86:87]
    v_pk_fma_f32 v[88:89], v[88:89], v[122:123], v[90:91]
    v_cvt_pk_bf16_f32 v160, v124, v125
    v_cvt_pk_bf16_f32 v161, v126, v127
    v_pk_fma_f32 v[76:77], v[78:79], v[108:109], v[76:77]
    v_pk_fma_f32 v[80:81], v[82:83], v[112:113], v[80:81]
    buffer_load_dwordx4 v[20:21], s[20:23], 0 idxen offen offset:1024 lds
    v_pk_fma_f32 v[84:85], v[86:87], v[116:117], v[84:85]
    v_pk_fma_f32 v[88:89], v[90:91], v[120:121], v[88:89]
    v_pk_fma_f32 v[108:109], v[108:109], v[110:111], v[110:111]
    v_pk_fma_f32 v[112:113], v[112:113], v[114:115], v[114:115]
    v_pk_fma_f32 v[116:117], v[116:117], v[118:119], v[118:119]
    v_pk_fma_f32 v[120:121], v[120:121], v[122:123], v[122:123]
    v_pk_mul_f32 v[124:125], v[76:77], v[112:113]
    buffer_load_dwordx4 v[22:23], s[20:23], 0 idxen offen offset:2048 lds
    v_pk_mul_f32 v[126:127], v[84:85], v[120:121]
    v_pk_mul_f32 v[128:129], v[108:109], v[112:113]
    v_pk_mul_f32 v[130:131], v[116:117], v[120:121]
    v_pk_fma_f32 v[124:125], v[80:81], v[108:109], v[124:125]
    v_pk_fma_f32 v[126:127], v[88:89], v[116:117], v[126:127]
    v_pk_mul_f32 v[124:125], v[124:125], v[130:131]
    v_pk_mul_f32 v[126:127], v[126:127], v[128:129]
    buffer_load_dwordx4 v[24:25], s[20:23], 0 idxen offen offset:3072 lds
    v_pk_mul_f32 v[128:129], v[128:129], v[130:131]
    s_setprio 1
    s_waitcnt lgkmcnt(0)
    v_mfma_f32_32x32x16_bf16 v[76:91], v[26:29], v[30:33], 0
    v_exp_f32 v108, v92
    v_exp_f32 v109, v93
    v_exp_f32 v110, v94
    v_exp_f32 v111, v95
    v_exp_f32 v112, v96
    v_exp_f32 v113, v97
    v_mfma_f32_32x32x16_bf16 v[76:91], v[132:135], v[148:151], v[76:91]
    v_max3_f32 v228, v228, v128, v129
    v_exp_f32 v114, v98
    v_exp_f32 v115, v99
    v_exp_f32 v116, v100
    v_exp_f32 v117, v101
    v_exp_f32 v118, v102
    v_exp_f32 v119, v103
    v_mfma_f32_32x32x16_bf16 v[76:91], v[136:139], v[152:155], v[76:91]
    v_exp_f32 v120, v104
    v_exp_f32 v121, v105
    v_exp_f32 v122, v106
    v_exp_f32 v123, v107
    v_rcp_f32 v128, v128
    v_rcp_f32 v129, v129
    s_setprio 3
    ds_read_b128 v[140:143], v16 offset:8192
    v_pk_add_f32 v[110:111], v[110:111], 1.0 op_sel_hi:[1,0]
    v_pk_add_f32 v[114:115], v[114:115], 1.0 op_sel_hi:[1,0]
    ds_read_b128 v[144:147], v17 offset:8192
    v_pk_add_f32 v[118:119], v[118:119], 1.0 op_sel_hi:[1,0]
    v_pk_add_f32 v[122:123], v[122:123], 1.0 op_sel_hi:[1,0]
    ds_read_b64_tr_b16 v[36:37], v10 offset:64
    v_pk_mul_f32 v[124:125], v[124:125], v[128:129]
    v_pk_mul_f32 v[126:127], v[126:127], v[128:129]
    ds_read_b64_tr_b16 v[166:167], v12
    v_pk_fma_f32 v[92:93], v[92:93], v[110:111], v[94:95]
    v_pk_fma_f32 v[96:97], v[96:97], v[114:115], v[98:99]
    ds_read_u8 v9, v6 offset:24
    v_pk_fma_f32 v[100:101], v[100:101], v[118:119], v[102:103]
    v_pk_fma_f32 v[104:105], v[104:105], v[122:123], v[106:107]
    ds_read_u16 v18, v4 offset:320
    v_cvt_pk_bf16_f32 v158, v124, v125
    v_cvt_pk_bf16_f32 v159, v126, v127
    ds_read_u16 v20, v4 offset:324
    v_pk_fma_f32 v[92:93], v[94:95], v[108:109], v[92:93]
    v_pk_fma_f32 v[96:97], v[98:99], v[112:113], v[96:97]
    ds_read_u16 v22, v4 offset:336
    v_pk_fma_f32 v[100:101], v[102:103], v[116:117], v[100:101]
    v_pk_fma_f32 v[104:105], v[106:107], v[120:121], v[104:105]
    ds_read_u16 v24, v4 offset:340
    v_pk_fma_f32 v[108:109], v[108:109], v[110:111], v[110:111]
    v_pk_fma_f32 v[112:113], v[112:113], v[114:115], v[114:115]
    v_pk_fma_f32 v[116:117], v[116:117], v[118:119], v[118:119]
    v_pk_fma_f32 v[120:121], v[120:121], v[122:123], v[122:123]
    v_pk_mul_f32 v[124:125], v[92:93], v[112:113]
    v_pk_mul_f32 v[126:127], v[100:101], v[120:121]
    v_pk_mul_f32 v[128:129], v[108:109], v[112:113]
    v_pk_mul_f32 v[130:131], v[116:117], v[120:121]
    v_pk_fma_f32 v[124:125], v[96:97], v[108:109], v[124:125]
    v_pk_fma_f32 v[126:127], v[104:105], v[116:117], v[126:127]
    v_pk_mul_f32 v[124:125], v[124:125], v[130:131]
    v_pk_mul_f32 v[126:127], v[126:127], v[128:129]
    s_sub_u32 s54, s54, 1
    v_pk_mul_f32 v[128:129], v[128:129], v[130:131]
    s_cbranch_scc1 k2_drain1
    s_setprio 0
    s_waitcnt lgkmcnt(0)
    v_mfma_f32_32x32x16_bf16 v[44:59], v[156:159], v[164:167], v[44:59]
    v_exp_f32 v108, v76
    v_exp_f32 v109, v77
    v_exp_f32 v110, v78
    v_exp_f32 v111, v79
    v_mfma_f32_32x32x16_bf16 v[92:107], v[26:29], v[34:37], 0
    v_exp_f32 v112, v80
    v_exp_f32 v113, v81
    v_exp_f32 v114, v82
    v_exp_f32 v115, v83
    v_mfma_f32_32x32x16_bf16 v[92:107], v[140:143], v[148:151], v[92:107]
    v_max3_f32 v228, v228, v128, v129
    v_exp_f32 v116, v84
    v_exp_f32 v117, v85
    v_exp_f32 v118, v86
    v_exp_f32 v119, v87
    v_mfma_f32_32x32x16_bf16 v[92:107], v[144:147], v[152:155], v[92:107]
    v_mad_u32_u24 v10, v9, s68, v7
    v_add_u32 v11, s69, v10
    v_exp_f32 v120, v88
    v_exp_f32 v121, v89
    v_exp_f32 v122, v90
    v_exp_f32 v123, v91
    v_rcp_f32 v128, v128
    v_rcp_f32 v129, v129
    s_setprio 2
    s_waitcnt vmcnt(4)
    v_pk_add_f32 v[110:111], v[110:111], 1.0 op_sel_hi:[1,0]
    ds_read_b128 v[132:135], v14 offset:0
    v_pk_add_f32 v[114:115], v[114:115], 1.0 op_sel_hi:[1,0]
    ds_read_b128 v[136:139], v15 offset:0
    v_pk_add_f32 v[118:119], v[118:119], 1.0 op_sel_hi:[1,0]
    ds_read_b64_tr_b16 v[32:33], v10
    v_pk_add_f32 v[122:123], v[122:123], 1.0 op_sel_hi:[1,0]
    ds_read_b128 v[26:29], v5 offset:1536
    v_pk_mul_f32 v[124:125], v[124:125], v[128:129]
    s_add_u32 m0, s53, 8192
    v_pk_mul_f32 v[126:127], v[126:127], v[128:129]
    v_pk_fma_f32 v[76:77], v[76:77], v[110:111], v[78:79]
    buffer_load_dwordx4 v[18:19], s[20:23], 0 idxen offen offset:0 lds
    v_pk_fma_f32 v[80:81], v[80:81], v[114:115], v[82:83]
    v_pk_fma_f32 v[84:85], v[84:85], v[118:119], v[86:87]
    v_pk_fma_f32 v[88:89], v[88:89], v[122:123], v[90:91]
    v_cvt_pk_bf16_f32 v162, v124, v125
    v_cvt_pk_bf16_f32 v163, v126, v127
    v_pk_fma_f32 v[76:77], v[78:79], v[108:109], v[76:77]
    v_pk_fma_f32 v[80:81], v[82:83], v[112:113], v[80:81]
    buffer_load_dwordx4 v[20:21], s[20:23], 0 idxen offen offset:1024 lds
    v_pk_fma_f32 v[84:85], v[86:87], v[116:117], v[84:85]
    v_pk_fma_f32 v[88:89], v[90:91], v[120:121], v[88:89]
    v_pk_fma_f32 v[108:109], v[108:109], v[110:111], v[110:111]
    v_pk_fma_f32 v[112:113], v[112:113], v[114:115], v[114:115]
    v_pk_fma_f32 v[116:117], v[116:117], v[118:119], v[118:119]
    v_pk_fma_f32 v[120:121], v[120:121], v[122:123], v[122:123]
    v_pk_mul_f32 v[124:125], v[76:77], v[112:113]
    buffer_load_dwordx4 v[22:23], s[20:23], 0 idxen offen offset:2048 lds
    v_pk_mul_f32 v[126:127], v[84:85], v[120:121]
    v_pk_mul_f32 v[128:129], v[108:109], v[112:113]
    v_pk_mul_f32 v[130:131], v[116:117], v[120:121]
    v_pk_fma_f32 v[124:125], v[80:81], v[108:109], v[124:125]
    v_pk_fma_f32 v[126:127], v[88:89], v[116:117], v[126:127]
    v_pk_mul_f32 v[124:125], v[124:125], v[130:131]
    v_pk_mul_f32 v[126:127], v[126:127], v[128:129]
    buffer_load_dwordx4 v[24:25], s[20:23], 0 idxen offen offset:3072 lds
    v_pk_mul_f32 v[128:129], v[128:129], v[130:131]
    s_setprio 0
    s_waitcnt lgkmcnt(0)
    v_mfma_f32_32x32x16_bf16 v[60:75], v[160:163], v[164:167], v[60:75]
    v_exp_f32 v108, v92
    v_exp_f32 v109, v93
    v_exp_f32 v110, v94
    v_exp_f32 v111, v95
    v_mfma_f32_32x32x16_bf16 v[76:91], v[26:29], v[30:33], 0
    v_exp_f32 v112, v96
    v_exp_f32 v113, v97
    v_exp_f32 v114, v98
    v_exp_f32 v115, v99
    v_mfma_f32_32x32x16_bf16 v[76:91], v[132:135], v[148:151], v[76:91]
    v_max3_f32 v228, v228, v128, v129
    v_exp_f32 v116, v100
    v_exp_f32 v117, v101
    v_exp_f32 v118, v102
    v_exp_f32 v119, v103
    v_mfma_f32_32x32x16_bf16 v[76:91], v[136:139], v[152:155], v[76:91]
    v_exp_f32 v120, v104
    v_exp_f32 v121, v105
    v_exp_f32 v122, v106
    v_exp_f32 v123, v107
    v_rcp_f32 v128, v128
    v_rcp_f32 v129, v129
    s_setprio 2
    ds_read_b128 v[140:143], v16 offset:0
    v_pk_add_f32 v[110:111], v[110:111], 1.0 op_sel_hi:[1,0]
    v_pk_add_f32 v[114:115], v[114:115], 1.0 op_sel_hi:[1,0]
    ds_read_b128 v[144:147], v17 offset:0
    v_pk_add_f32 v[118:119], v[118:119], 1.0 op_sel_hi:[1,0]
    v_pk_add_f32 v[122:123], v[122:123], 1.0 op_sel_hi:[1,0]
    ds_read_b64_tr_b16 v[36:37], v10 offset:64
    v_pk_mul_f32 v[124:125], v[124:125], v[128:129]
    v_pk_mul_f32 v[126:127], v[126:127], v[128:129]
    ds_read_b64_tr_b16 v[164:165], v13
    v_pk_fma_f32 v[92:93], v[92:93], v[110:111], v[94:95]
    v_pk_fma_f32 v[96:97], v[96:97], v[114:115], v[98:99]
    ds_read_u8 v9, v6 offset:32
    v_pk_fma_f32 v[100:101], v[100:101], v[118:119], v[102:103]
    v_pk_fma_f32 v[104:105], v[104:105], v[122:123], v[106:107]
    ds_read_u16 v18, v4 offset:384
    v_cvt_pk_bf16_f32 v156, v124, v125
    v_cvt_pk_bf16_f32 v157, v126, v127
    ds_read_u16 v20, v4 offset:388
    v_pk_fma_f32 v[92:93], v[94:95], v[108:109], v[92:93]
    v_pk_fma_f32 v[96:97], v[98:99], v[112:113], v[96:97]
    ds_read_u16 v22, v4 offset:400
    v_pk_fma_f32 v[100:101], v[102:103], v[116:117], v[100:101]
    v_pk_fma_f32 v[104:105], v[106:107], v[120:121], v[104:105]
    ds_read_u16 v24, v4 offset:404
    v_pk_fma_f32 v[108:109], v[108:109], v[110:111], v[110:111]
    v_pk_fma_f32 v[112:113], v[112:113], v[114:115], v[114:115]
    v_pk_fma_f32 v[116:117], v[116:117], v[118:119], v[118:119]
    v_pk_fma_f32 v[120:121], v[120:121], v[122:123], v[122:123]
    v_pk_mul_f32 v[124:125], v[92:93], v[112:113]
    v_pk_mul_f32 v[126:127], v[100:101], v[120:121]
    v_pk_mul_f32 v[128:129], v[108:109], v[112:113]
    v_pk_mul_f32 v[130:131], v[116:117], v[120:121]
    v_pk_fma_f32 v[124:125], v[96:97], v[108:109], v[124:125]
    v_pk_fma_f32 v[126:127], v[104:105], v[116:117], v[126:127]
    v_pk_mul_f32 v[124:125], v[124:125], v[130:131]
    v_pk_mul_f32 v[126:127], v[126:127], v[128:129]
    v_add_u32 v4, 192, v4
    v_add_u32 v5, v8, v5
    v_add_u32 v6, 24, v6
    s_sub_u32 s54, s54, 1
    v_pk_mul_f32 v[128:129], v[128:129], v[130:131]
    s_cbranch_scc1 k2_drain
    s_setprio 1
    s_waitcnt lgkmcnt(0)
    v_mfma_f32_32x32x16_bf16 v[92:107], v[26:29], v[34:37], 0
    v_exp_f32 v108, v76
    v_exp_f32 v109, v77
    v_exp_f32 v110, v78
    v_exp_f32 v111, v79
    v_exp_f32 v112, v80
    v_exp_f32 v113, v81
    v_mfma_f32_32x32x16_bf16 v[92:107], v[140:143], v[148:151], v[92:107]
    v_max3_f32 v228, v228, v128, v129
    v_exp_f32 v114, v82
    v_exp_f32 v115, v83
    v_exp_f32 v116, v84
    v_exp_f32 v117, v85
    v_exp_f32 v118, v86
    v_exp_f32 v119, v87
    v_mfma_f32_32x32x16_bf16 v[92:107], v[144:147], v[152:155], v[92:107]
    v_mad_u32_u24 v10, v9, s68, v7
    v_add_u32 v12, s69, v10
    v_exp_f32 v120, v88
    v_exp_f32 v121, v89
    v_exp_f32 v122, v90
    v_exp_f32 v123, v91
    v_rcp_f32 v128, v128
    v_rcp_f32 v129, v129
    s_setprio 3
    s_waitcnt vmcnt(4)
    v_pk_add_f32 v[110:111], v[110:111], 1.0 op_sel_hi:[1,0]
    ds_read_b128 v[132:135], v14 offset:4096
    v_pk_add_f32 v[114:115], v[114:115], 1.0 op_sel_hi:[1,0]
    ds_read_b128 v[136:139], v15 offset:4096
    v_pk_add_f32 v[118:119], v[118:119], 1.0 op_sel_hi:[1,0]
    ds_read_b64_tr_b16 v[32:33], v10
    v_pk_add_f32 v[122:123], v[122:123], 1.0 op_sel_hi:[1,0]
    ds_read_b128 v[26:29], v5 offset:512
    v_pk_mul_f32 v[124:125], v[124:125], v[128:129]
    s_add_u32 m0, s53, 0
    v_pk_mul_f32 v[126:127], v[126:127], v[128:129]
    v_pk_fma_f32 v[76:77], v[76:77], v[110:111], v[78:79]
    buffer_load_dwordx4 v[18:19], s[20:23], 0 idxen offen offset:0 lds
    v_pk_fma_f32 v[80:81], v[80:81], v[114:115], v[82:83]
    v_pk_fma_f32 v[84:85], v[84:85], v[118:119], v[86:87]
    v_pk_fma_f32 v[88:89], v[88:89], v[122:123], v[90:91]
    v_cvt_pk_bf16_f32 v160, v124, v125
    v_cvt_pk_bf16_f32 v161, v126, v127
    v_pk_fma_f32 v[76:77], v[78:79], v[108:109], v[76:77]
    v_pk_fma_f32 v[80:81], v[82:83], v[112:113], v[80:81]
    buffer_load_dwordx4 v[20:21], s[20:23], 0 idxen offen offset:1024 lds
    v_pk_fma_f32 v[84:85], v[86:87], v[116:117], v[84:85]
    v_pk_fma_f32 v[88:89], v[90:91], v[120:121], v[88:89]
    v_pk_fma_f32 v[108:109], v[108:109], v[110:111], v[110:111]
    v_pk_fma_f32 v[112:113], v[112:113], v[114:115], v[114:115]
    v_pk_fma_f32 v[116:117], v[116:117], v[118:119], v[118:119]
    v_pk_fma_f32 v[120:121], v[120:121], v[122:123], v[122:123]
    v_pk_mul_f32 v[124:125], v[76:77], v[112:113]
    buffer_load_dwordx4 v[22:23], s[20:23], 0 idxen offen offset:2048 lds
    v_pk_mul_f32 v[126:127], v[84:85], v[120:121]
    v_pk_mul_f32 v[128:129], v[108:109], v[112:113]
    v_pk_mul_f32 v[130:131], v[116:117], v[120:121]
    v_pk_fma_f32 v[124:125], v[80:81], v[108:109], v[124:125]
    v_pk_fma_f32 v[126:127], v[88:89], v[116:117], v[126:127]
    v_pk_mul_f32 v[124:125], v[124:125], v[130:131]
    v_pk_mul_f32 v[126:127], v[126:127], v[128:129]
    buffer_load_dwordx4 v[24:25], s[20:23], 0 idxen offen offset:3072 lds
    v_pk_mul_f32 v[128:129], v[128:129], v[130:131]
    s_setprio 1
    s_waitcnt lgkmcnt(0)
    v_mfma_f32_32x32x16_bf16 v[76:91], v[26:29], v[30:33], 0
    v_exp_f32 v108, v92
    v_exp_f32 v109, v93
    v_exp_f32 v110, v94
    v_exp_f32 v111, v95
    v_exp_f32 v112, v96
    v_exp_f32 v113, v97
    v_mfma_f32_32x32x16_bf16 v[76:91], v[132:135], v[148:151], v[76:91]
    v_max3_f32 v228, v228, v128, v129
    v_exp_f32 v114, v98
    v_exp_f32 v115, v99
    v_exp_f32 v116, v100
    v_exp_f32 v117, v101
    v_exp_f32 v118, v102
    v_exp_f32 v119, v103
    v_mfma_f32_32x32x16_bf16 v[76:91], v[136:139], v[152:155], v[76:91]
    v_exp_f32 v120, v104
    v_exp_f32 v121, v105
    v_exp_f32 v122, v106
    v_exp_f32 v123, v107
    v_rcp_f32 v128, v128
    v_rcp_f32 v129, v129
    s_setprio 3
    ds_read_b128 v[140:143], v16 offset:4096
    v_pk_add_f32 v[110:111], v[110:111], 1.0 op_sel_hi:[1,0]
    v_pk_add_f32 v[114:115], v[114:115], 1.0 op_sel_hi:[1,0]
    ds_read_b128 v[144:147], v17 offset:4096
    v_pk_add_f32 v[118:119], v[118:119], 1.0 op_sel_hi:[1,0]
    v_pk_add_f32 v[122:123], v[122:123], 1.0 op_sel_hi:[1,0]
    ds_read_b64_tr_b16 v[36:37], v10 offset:64
    v_pk_mul_f32 v[124:125], v[124:125], v[128:129]
    v_pk_mul_f32 v[126:127], v[126:127], v[128:129]
    ds_read_b64_tr_b16 v[166:167], v11
    v_pk_fma_f32 v[92:93], v[92:93], v[110:111], v[94:95]
    v_pk_fma_f32 v[96:97], v[96:97], v[114:115], v[98:99]
    ds_read_u8 v9, v6 offset:16
    v_pk_fma_f32 v[100:101], v[100:101], v[118:119], v[102:103]
    v_pk_fma_f32 v[104:105], v[104:105], v[122:123], v[106:107]
    ds_read_u16 v18, v4 offset:256
    v_cvt_pk_bf16_f32 v158, v124, v125
    v_cvt_pk_bf16_f32 v159, v126, v127
    ds_read_u16 v20, v4 offset:260
    v_pk_fma_f32 v[92:93], v[94:95], v[108:109], v[92:93]
    v_pk_fma_f32 v[96:97], v[98:99], v[112:113], v[96:97]
    ds_read_u16 v22, v4 offset:272
    v_pk_fma_f32 v[100:101], v[102:103], v[116:117], v[100:101]
    v_pk_fma_f32 v[104:105], v[106:107], v[120:121], v[104:105]
    ds_read_u16 v24, v4 offset:276
    v_pk_fma_f32 v[108:109], v[108:109], v[110:111], v[110:111]
    v_pk_fma_f32 v[112:113], v[112:113], v[114:115], v[114:115]
    v_pk_fma_f32 v[116:117], v[116:117], v[118:119], v[118:119]
    v_pk_fma_f32 v[120:121], v[120:121], v[122:123], v[122:123]
    v_pk_mul_f32 v[124:125], v[92:93], v[112:113]
    v_pk_mul_f32 v[126:127], v[100:101], v[120:121]
    v_pk_mul_f32 v[128:129], v[108:109], v[112:113]
    v_pk_mul_f32 v[130:131], v[116:117], v[120:121]
    v_pk_fma_f32 v[124:125], v[96:97], v[108:109], v[124:125]
    v_pk_fma_f32 v[126:127], v[104:105], v[116:117], v[126:127]
    v_pk_mul_f32 v[124:125], v[124:125], v[130:131]
    v_pk_mul_f32 v[126:127], v[126:127], v[128:129]
    s_sub_u32 s54, s54, 1
    v_pk_mul_f32 v[128:129], v[128:129], v[130:131]
    s_cbranch_scc1 k2_drain1
    s_setprio 1
    s_waitcnt lgkmcnt(0)
    v_mfma_f32_32x32x16_bf16 v[44:59], v[156:159], v[164:167], v[44:59]
    v_exp_f32 v108, v76
    v_exp_f32 v109, v77
    v_exp_f32 v110, v78
    v_exp_f32 v111, v79
    v_mfma_f32_32x32x16_bf16 v[92:107], v[26:29], v[34:37], 0
    v_exp_f32 v112, v80
    v_exp_f32 v113, v81
    v_exp_f32 v114, v82
    v_exp_f32 v115, v83
    v_mfma_f32_32x32x16_bf16 v[92:107], v[140:143], v[148:151], v[92:107]
    v_max3_f32 v228, v228, v128, v129
    v_exp_f32 v116, v84
    v_exp_f32 v117, v85
    v_exp_f32 v118, v86
    v_exp_f32 v119, v87
    v_mfma_f32_32x32x16_bf16 v[92:107], v[144:147], v[152:155], v[92:107]
    v_mad_u32_u24 v10, v9, s68, v7
    v_add_u32 v13, s69, v10
    v_exp_f32 v120, v88
    v_exp_f32 v121, v89
    v_exp_f32 v122, v90
    v_exp_f32 v123, v91
    v_rcp_f32 v128, v128
    v_rcp_f32 v129, v129
    s_setprio 3
    s_waitcnt vmcnt(4)
    v_pk_add_f32 v[110:111], v[110:111], 1.0 op_sel_hi:[1,0]
    ds_read_b128 v[132:135], v14 offset:8192
    v_pk_add_f32 v[114:115], v[114:115], 1.0 op_sel_hi:[1,0]
    ds_read_b128 v[136:139], v15 offset:8192
    v_pk_add_f32 v[118:119], v[118:119], 1.0 op_sel_hi:[1,0]
    ds_read_b64_tr_b16 v[32:33], v10
    v_pk_add_f32 v[122:123], v[122:123], 1.0 op_sel_hi:[1,0]
    ds_read_b128 v[26:29], v5 offset:1024
    v_pk_mul_f32 v[124:125], v[124:125], v[128:129]
    s_add_u32 m0, s53, 4096
    v_pk_mul_f32 v[126:127], v[126:127], v[128:129]
    v_pk_fma_f32 v[76:77], v[76:77], v[110:111], v[78:79]
    buffer_load_dwordx4 v[18:19], s[20:23], 0 idxen offen offset:0 lds
    v_pk_fma_f32 v[80:81], v[80:81], v[114:115], v[82:83]
    v_pk_fma_f32 v[84:85], v[84:85], v[118:119], v[86:87]
    v_pk_fma_f32 v[88:89], v[88:89], v[122:123], v[90:91]
    v_cvt_pk_bf16_f32 v162, v124, v125
    v_cvt_pk_bf16_f32 v163, v126, v127
    v_pk_fma_f32 v[76:77], v[78:79], v[108:109], v[76:77]
    v_pk_fma_f32 v[80:81], v[82:83], v[112:113], v[80:81]
    buffer_load_dwordx4 v[20:21], s[20:23], 0 idxen offen offset:1024 lds
    v_pk_fma_f32 v[84:85], v[86:87], v[116:117], v[84:85]
    v_pk_fma_f32 v[88:89], v[90:91], v[120:121], v[88:89]
    v_pk_fma_f32 v[108:109], v[108:109], v[110:111], v[110:111]
    v_pk_fma_f32 v[112:113], v[112:113], v[114:115], v[114:115]
    v_pk_fma_f32 v[116:117], v[116:117], v[118:119], v[118:119]
    v_pk_fma_f32 v[120:121], v[120:121], v[122:123], v[122:123]
    v_pk_mul_f32 v[124:125], v[76:77], v[112:113]
    buffer_load_dwordx4 v[22:23], s[20:23], 0 idxen offen offset:2048 lds
    v_pk_mul_f32 v[126:127], v[84:85], v[120:121]
    v_pk_mul_f32 v[128:129], v[108:109], v[112:113]
    v_pk_mul_f32 v[130:131], v[116:117], v[120:121]
    v_pk_fma_f32 v[124:125], v[80:81], v[108:109], v[124:125]
    v_pk_fma_f32 v[126:127], v[88:89], v[116:117], v[126:127]
    v_pk_mul_f32 v[124:125], v[124:125], v[130:131]
    v_pk_mul_f32 v[126:127], v[126:127], v[128:129]
    buffer_load_dwordx4 v[24:25], s[20:23], 0 idxen offen offset:3072 lds
    v_pk_mul_f32 v[128:129], v[128:129], v[130:131]
    s_setprio 1
    s_waitcnt lgkmcnt(0)
    v_mfma_f32_32x32x16_bf16 v[60:75], v[160:163], v[164:167], v[60:75]
    v_exp_f32 v108, v92
    v_exp_f32 v109, v93
    v_exp_f32 v110, v94
    v_exp_f32 v111, v95
    v_mfma_f32_32x32x16_bf16 v[76:91], v[26:29], v[30:33], 0
    v_exp_f32 v112, v96
    v_exp_f32 v113, v97
    v_exp_f32 v114, v98
    v_exp_f32 v115, v99
    v_mfma_f32_32x32x16_bf16 v[76:91], v[132:135], v[148:151], v[76:91]
    v_max3_f32 v228, v228, v128, v129
    v_exp_f32 v116, v100
    v_exp_f32 v117, v101
    v_exp_f32 v118, v102
    v_exp_f32 v119, v103
    v_mfma_f32_32x32x16_bf16 v[76:91], v[136:139], v[152:155], v[76:91]
    v_exp_f32 v120, v104
    v_exp_f32 v121, v105
    v_exp_f32 v122, v106
    v_exp_f32 v123, v107
    v_rcp_f32 v128, v128
    v_rcp_f32 v129, v129
    s_setprio 3
    ds_read_b128 v[140:143], v16 offset:8192
    v_pk_add_f32 v[110:111], v[110:111], 1.0 op_sel_hi:[1,0]
    v_pk_add_f32 v[114:115], v[114:115], 1.0 op_sel_hi:[1,0]
    ds_read_b128 v[144:147], v17 offset:8192
    v_pk_add_f32 v[118:119], v[118:119], 1.0 op_sel_hi:[1,0]
    v_pk_add_f32 v[122:123], v[122:123], 1.0 op_sel_hi:[1,0]
    ds_read_b64_tr_b16 v[36:37], v10 offset:64
    v_pk_mul_f32 v[124:125], v[124:125], v[128:129]
    v_pk_mul_f32 v[126:127], v[126:127], v[128:129]
    ds_read_b64_tr_b16 v[164:165], v12
    v_pk_fma_f32 v[92:93], v[92:93], v[110:111], v[94:95]
    v_pk_fma_f32 v[96:97], v[96:97], v[114:115], v[98:99]
    ds_read_u8 v9, v6 offset:24
    v_pk_fma_f32 v[100:101], v[100:101], v[118:119], v[102:103]
    v_pk_fma_f32 v[104:105], v[104:105], v[122:123], v[106:107]
    ds_read_u16 v18, v4 offset:320
    v_cvt_pk_bf16_f32 v156, v124, v125
    v_cvt_pk_bf16_f32 v157, v126, v127
    ds_read_u16 v20, v4 offset:324
    v_pk_fma_f32 v[92:93], v[94:95], v[108:109], v[92:93]
    v_pk_fma_f32 v[96:97], v[98:99], v[112:113], v[96:97]
    ds_read_u16 v22, v4 offset:336
    v_pk_fma_f32 v[100:101], v[102:103], v[116:117], v[100:101]
    v_pk_fma_f32 v[104:105], v[106:107], v[120:121], v[104:105]
    ds_read_u16 v24, v4 offset:340
    v_pk_fma_f32 v[108:109], v[108:109], v[110:111], v[110:111]
    v_pk_fma_f32 v[112:113], v[112:113], v[114:115], v[114:115]
    v_pk_fma_f32 v[116:117], v[116:117], v[118:119], v[118:119]
    v_pk_fma_f32 v[120:121], v[120:121], v[122:123], v[122:123]
    v_pk_mul_f32 v[124:125], v[92:93], v[112:113]
    v_pk_mul_f32 v[126:127], v[100:101], v[120:121]
    v_pk_mul_f32 v[128:129], v[108:109], v[112:113]
    v_pk_mul_f32 v[130:131], v[116:117], v[120:121]
    v_pk_fma_f32 v[124:125], v[96:97], v[108:109], v[124:125]
    v_pk_fma_f32 v[126:127], v[104:105], v[116:117], v[126:127]
    v_pk_mul_f32 v[124:125], v[124:125], v[130:131]
    v_pk_mul_f32 v[126:127], v[126:127], v[128:129]
    s_sub_u32 s54, s54, 1
    v_pk_mul_f32 v[128:129], v[128:129], v[130:131]
    s_cbranch_scc1 k2_drain
    s_setprio 0
    s_waitcnt lgkmcnt(0)
    v_mfma_f32_32x32x16_bf16 v[92:107], v[26:29], v[34:37], 0
    v_exp_f32 v108, v76
    v_exp_f32 v109, v77
    v_exp_f32 v110, v78
    v_exp_f32 v111, v79
    v_exp_f32 v112, v80
    v_exp_f32 v113, v81
    v_mfma_f32_32x32x16_bf16 v[92:107], v[140:143], v[148:151], v[92:107]
    v_max3_f32 v228, v228, v128, v129
    v_exp_f32 v114, v82
    v_exp_f32 v115, v83
    v_exp_f32 v116, v84
    v_exp_f32 v117, v85
    v_exp_f32 v118, v86
    v_exp_f32 v119, v87
    v_mfma_f32_32x32x16_bf16 v[92:107], v[144:147], v[152:155], v[92:107]
    v_mad_u32_u24 v10, v9, s68, v7
    v_add_u32 v11, s69, v10
    v_exp_f32 v120, v88
    v_exp_f32 v121, v89
    v_exp_f32 v122, v90
    v_exp_f32 v123, v91
    v_rcp_f32 v128, v128
    v_rcp_f32 v129, v129
    s_setprio 2
    s_waitcnt vmcnt(4)
    v_pk_add_f32 v[110:111], v[110:111], 1.0 op_sel_hi:[1,0]
    ds_read_b128 v[132:135], v14 offset:0
    v_pk_add_f32 v[114:115], v[114:115], 1.0 op_sel_hi:[1,0]
    ds_read_b128 v[136:139], v15 offset:0
    v_pk_add_f32 v[118:119], v[118:119], 1.0 op_sel_hi:[1,0]
    ds_read_b64_tr_b16 v[32:33], v10
    v_pk_add_f32 v[122:123], v[122:123], 1.0 op_sel_hi:[1,0]
    ds_read_b128 v[26:29], v5 offset:1536
    v_pk_mul_f32 v[124:125], v[124:125], v[128:129]
    s_add_u32 m0, s53, 8192
    v_pk_mul_f32 v[126:127], v[126:127], v[128:129]
    v_pk_fma_f32 v[76:77], v[76:77], v[110:111], v[78:79]
    buffer_load_dwordx4 v[18:19], s[20:23], 0 idxen offen offset:0 lds
    v_pk_fma_f32 v[80:81], v[80:81], v[114:115], v[82:83]
    v_pk_fma_f32 v[84:85], v[84:85], v[118:119], v[86:87]
    v_pk_fma_f32 v[88:89], v[88:89], v[122:123], v[90:91]
    v_cvt_pk_bf16_f32 v160, v124, v125
    v_cvt_pk_bf16_f32 v161, v126, v127
    v_pk_fma_f32 v[76:77], v[78:79], v[108:109], v[76:77]
    v_pk_fma_f32 v[80:81], v[82:83], v[112:113], v[80:81]
    buffer_load_dwordx4 v[20:21], s[20:23], 0 idxen offen offset:1024 lds
    v_pk_fma_f32 v[84:85], v[86:87], v[116:117], v[84:85]
    v_pk_fma_f32 v[88:89], v[90:91], v[120:121], v[88:89]
    v_pk_fma_f32 v[108:109], v[108:109], v[110:111], v[110:111]
    v_pk_fma_f32 v[112:113], v[112:113], v[114:115], v[114:115]
    v_pk_fma_f32 v[116:117], v[116:117], v[118:119], v[118:119]
    v_pk_fma_f32 v[120:121], v[120:121], v[122:123], v[122:123]
    v_pk_mul_f32 v[124:125], v[76:77], v[112:113]
    buffer_load_dwordx4 v[22:23], s[20:23], 0 idxen offen offset:2048 lds
    v_pk_mul_f32 v[126:127], v[84:85], v[120:121]
    v_pk_mul_f32 v[128:129], v[108:109], v[112:113]
    v_pk_mul_f32 v[130:131], v[116:117], v[120:121]
    v_pk_fma_f32 v[124:125], v[80:81], v[108:109], v[124:125]
    v_pk_fma_f32 v[126:127], v[88:89], v[116:117], v[126:127]
    v_pk_mul_f32 v[124:125], v[124:125], v[130:131]
    v_pk_mul_f32 v[126:127], v[126:127], v[128:129]
    buffer_load_dwordx4 v[24:25], s[20:23], 0 idxen offen offset:3072 lds
    v_pk_mul_f32 v[128:129], v[128:129], v[130:131]
    s_setprio 0
    s_waitcnt lgkmcnt(0)
    v_mfma_f32_32x32x16_bf16 v[76:91], v[26:29], v[30:33], 0
    v_exp_f32 v108, v92
    v_exp_f32 v109, v93
    v_exp_f32 v110, v94
    v_exp_f32 v111, v95
    v_exp_f32 v112, v96
    v_exp_f32 v113, v97
    v_mfma_f32_32x32x16_bf16 v[76:91], v[132:135], v[148:151], v[76:91]
    v_max3_f32 v228, v228, v128, v129
    v_exp_f32 v114, v98
    v_exp_f32 v115, v99
    v_exp_f32 v116, v100
    v_exp_f32 v117, v101
    v_exp_f32 v118, v102
    v_exp_f32 v119, v103
    v_mfma_f32_32x32x16_bf16 v[76:91], v[136:139], v[152:155], v[76:91]
    v_exp_f32 v120, v104
    v_exp_f32 v121, v105
    v_exp_f32 v122, v106
    v_exp_f32 v123, v107
    v_rcp_f32 v128, v128
    v_rcp_f32 v129, v129
    s_setprio 2
    ds_read_b128 v[140:143], v16 offset:0
    v_pk_add_f32 v[110:111], v[110:111], 1.0 op_sel_hi:[1,0]
    v_pk_add_f32 v[114:115], v[114:115], 1.0 op_sel_hi:[1,0]
    ds_read_b128 v[144:147], v17 offset:0
    v_pk_add_f32 v[118:119], v[118:119], 1.0 op_sel_hi:[1,0]
    v_pk_add_f32 v[122:123], v[122:123], 1.0 op_sel_hi:[1,0]
    ds_read_b64_tr_b16 v[36:37], v10 offset:64
    v_pk_mul_f32 v[124:125], v[124:125], v[128:129]
    v_pk_mul_f32 v[126:127], v[126:127], v[128:129]
    ds_read_b64_tr_b16 v[166:167], v13
    v_pk_fma_f32 v[92:93], v[92:93], v[110:111], v[94:95]
    v_pk_fma_f32 v[96:97], v[96:97], v[114:115], v[98:99]
    ds_read_u8 v9, v6 offset:32
    v_pk_fma_f32 v[100:101], v[100:101], v[118:119], v[102:103]
    v_pk_fma_f32 v[104:105], v[104:105], v[122:123], v[106:107]
    ds_read_u16 v18, v4 offset:384
    v_cvt_pk_bf16_f32 v158, v124, v125
    v_cvt_pk_bf16_f32 v159, v126, v127
    ds_read_u16 v20, v4 offset:388
    v_pk_fma_f32 v[92:93], v[94:95], v[108:109], v[92:93]
    v_pk_fma_f32 v[96:97], v[98:99], v[112:113], v[96:97]
    ds_read_u16 v22, v4 offset:400
    v_pk_fma_f32 v[100:101], v[102:103], v[116:117], v[100:101]
    v_pk_fma_f32 v[104:105], v[106:107], v[120:121], v[104:105]
    ds_read_u16 v24, v4 offset:404
    v_pk_fma_f32 v[108:109], v[108:109], v[110:111], v[110:111]
    v_pk_fma_f32 v[112:113], v[112:113], v[114:115], v[114:115]
    v_pk_fma_f32 v[116:117], v[116:117], v[118:119], v[118:119]
    v_pk_fma_f32 v[120:121], v[120:121], v[122:123], v[122:123]
    v_pk_mul_f32 v[124:125], v[92:93], v[112:113]
    v_pk_mul_f32 v[126:127], v[100:101], v[120:121]
    v_pk_mul_f32 v[128:129], v[108:109], v[112:113]
    v_pk_mul_f32 v[130:131], v[116:117], v[120:121]
    v_pk_fma_f32 v[124:125], v[96:97], v[108:109], v[124:125]
    v_pk_fma_f32 v[126:127], v[104:105], v[116:117], v[126:127]
    v_pk_mul_f32 v[124:125], v[124:125], v[130:131]
    v_pk_mul_f32 v[126:127], v[126:127], v[128:129]
    v_add_u32 v4, 192, v4
    v_add_u32 v5, v8, v5
    v_add_u32 v6, 24, v6
    s_sub_u32 s54, s54, 1
    v_pk_mul_f32 v[128:129], v[128:129], v[130:131]
    s_cbranch_scc1 k2_drain1
    s_setprio 1
    s_waitcnt lgkmcnt(0)
    v_mfma_f32_32x32x16_bf16 v[44:59], v[156:159], v[164:167], v[44:59]
    v_exp_f32 v108, v76
    v_exp_f32 v109, v77
    v_exp_f32 v110, v78
    v_exp_f32 v111, v79
    v_mfma_f32_32x32x16_bf16 v[92:107], v[26:29], v[34:37], 0
    v_exp_f32 v112, v80
    v_exp_f32 v113, v81
    v_exp_f32 v114, v82
    v_exp_f32 v115, v83
    v_mfma_f32_32x32x16_bf16 v[92:107], v[140:143], v[148:151], v[92:107]
    v_max3_f32 v228, v228, v128, v129
    v_exp_f32 v116, v84
    v_exp_f32 v117, v85
    v_exp_f32 v118, v86
    v_exp_f32 v119, v87
    v_mfma_f32_32x32x16_bf16 v[92:107], v[144:147], v[152:155], v[92:107]
    v_mad_u32_u24 v10, v9, s68, v7
    v_add_u32 v12, s69, v10
    v_exp_f32 v120, v88
    v_exp_f32 v121, v89
    v_exp_f32 v122, v90
    v_exp_f32 v123, v91
    v_rcp_f32 v128, v128
    v_rcp_f32 v129, v129
    s_setprio 3
    s_waitcnt vmcnt(4)
    v_pk_add_f32 v[110:111], v[110:111], 1.0 op_sel_hi:[1,0]
    ds_read_b128 v[132:135], v14 offset:4096
    v_pk_add_f32 v[114:115], v[114:115], 1.0 op_sel_hi:[1,0]
    ds_read_b128 v[136:139], v15 offset:4096
    v_pk_add_f32 v[118:119], v[118:119], 1.0 op_sel_hi:[1,0]
    ds_read_b64_tr_b16 v[32:33], v10
    v_pk_add_f32 v[122:123], v[122:123], 1.0 op_sel_hi:[1,0]
    ds_read_b128 v[26:29], v5 offset:512
    v_pk_mul_f32 v[124:125], v[124:125], v[128:129]
    s_add_u32 m0, s53, 0
    v_pk_mul_f32 v[126:127], v[126:127], v[128:129]
    v_pk_fma_f32 v[76:77], v[76:77], v[110:111], v[78:79]
    buffer_load_dwordx4 v[18:19], s[20:23], 0 idxen offen offset:0 lds
    v_pk_fma_f32 v[80:81], v[80:81], v[114:115], v[82:83]
    v_pk_fma_f32 v[84:85], v[84:85], v[118:119], v[86:87]
    v_pk_fma_f32 v[88:89], v[88:89], v[122:123], v[90:91]
    v_cvt_pk_bf16_f32 v162, v124, v125
    v_cvt_pk_bf16_f32 v163, v126, v127
    v_pk_fma_f32 v[76:77], v[78:79], v[108:109], v[76:77]
    v_pk_fma_f32 v[80:81], v[82:83], v[112:113], v[80:81]
    buffer_load_dwordx4 v[20:21], s[20:23], 0 idxen offen offset:1024 lds
    v_pk_fma_f32 v[84:85], v[86:87], v[116:117], v[84:85]
    v_pk_fma_f32 v[88:89], v[90:91], v[120:121], v[88:89]
    v_pk_fma_f32 v[108:109], v[108:109], v[110:111], v[110:111]
    v_pk_fma_f32 v[112:113], v[112:113], v[114:115], v[114:115]
    v_pk_fma_f32 v[116:117], v[116:117], v[118:119], v[118:119]
    v_pk_fma_f32 v[120:121], v[120:121], v[122:123], v[122:123]
    v_pk_mul_f32 v[124:125], v[76:77], v[112:113]
    buffer_load_dwordx4 v[22:23], s[20:23], 0 idxen offen offset:2048 lds
    v_pk_mul_f32 v[126:127], v[84:85], v[120:121]
    v_pk_mul_f32 v[128:129], v[108:109], v[112:113]
    v_pk_mul_f32 v[130:131], v[116:117], v[120:121]
    v_pk_fma_f32 v[124:125], v[80:81], v[108:109], v[124:125]
    v_pk_fma_f32 v[126:127], v[88:89], v[116:117], v[126:127]
    v_pk_mul_f32 v[124:125], v[124:125], v[130:131]
    v_pk_mul_f32 v[126:127], v[126:127], v[128:129]
    buffer_load_dwordx4 v[24:25], s[20:23], 0 idxen offen offset:3072 lds
    v_pk_mul_f32 v[128:129], v[128:129], v[130:131]
    s_setprio 1
    s_waitcnt lgkmcnt(0)
    v_mfma_f32_32x32x16_bf16 v[60:75], v[160:163], v[164:167], v[60:75]
    v_exp_f32 v108, v92
    v_exp_f32 v109, v93
    v_exp_f32 v110, v94
    v_exp_f32 v111, v95
    v_mfma_f32_32x32x16_bf16 v[76:91], v[26:29], v[30:33], 0
    v_exp_f32 v112, v96
    v_exp_f32 v113, v97
    v_exp_f32 v114, v98
    v_exp_f32 v115, v99
    v_mfma_f32_32x32x16_bf16 v[76:91], v[132:135], v[148:151], v[76:91]
    v_max3_f32 v228, v228, v128, v129
    v_exp_f32 v116, v100
    v_exp_f32 v117, v101
    v_exp_f32 v118, v102
    v_exp_f32 v119, v103
    v_mfma_f32_32x32x16_bf16 v[76:91], v[136:139], v[152:155], v[76:91]
    v_exp_f32 v120, v104
    v_exp_f32 v121, v105
    v_exp_f32 v122, v106
    v_exp_f32 v123, v107
    v_rcp_f32 v128, v128
    v_rcp_f32 v129, v129
    s_setprio 3
    ds_read_b128 v[140:143], v16 offset:4096
    v_pk_add_f32 v[110:111], v[110:111], 1.0 op_sel_hi:[1,0]
    v_pk_add_f32 v[114:115], v[114:115], 1.0 op_sel_hi:[1,0]
    ds_read_b128 v[144:147], v17 offset:4096
    v_pk_add_f32 v[118:119], v[118:119], 1.0 op_sel_hi:[1,0]
    v_pk_add_f32 v[122:123], v[122:123], 1.0 op_sel_hi:[1,0]
    ds_read_b64_tr_b16 v[36:37], v10 offset:64
    v_pk_mul_f32 v[124:125], v[124:125], v[128:129]
    v_pk_mul_f32 v[126:127], v[126:127], v[128:129]
    ds_read_b64_tr_b16 v[164:165], v11
    v_pk_fma_f32 v[92:93], v[92:93], v[110:111], v[94:95]
    v_pk_fma_f32 v[96:97], v[96:97], v[114:115], v[98:99]
    ds_read_u8 v9, v6 offset:16
    v_pk_fma_f32 v[100:101], v[100:101], v[118:119], v[102:103]
    v_pk_fma_f32 v[104:105], v[104:105], v[122:123], v[106:107]
    ds_read_u16 v18, v4 offset:256
    v_cvt_pk_bf16_f32 v156, v124, v125
    v_cvt_pk_bf16_f32 v157, v126, v127
    ds_read_u16 v20, v4 offset:260
    v_pk_fma_f32 v[92:93], v[94:95], v[108:109], v[92:93]
    v_pk_fma_f32 v[96:97], v[98:99], v[112:113], v[96:97]
    ds_read_u16 v22, v4 offset:272
    v_pk_fma_f32 v[100:101], v[102:103], v[116:117], v[100:101]
    v_pk_fma_f32 v[104:105], v[106:107], v[120:121], v[104:105]
    ds_read_u16 v24, v4 offset:276
    v_pk_fma_f32 v[108:109], v[108:109], v[110:111], v[110:111]
    v_pk_fma_f32 v[112:113], v[112:113], v[114:115], v[114:115]
    v_pk_fma_f32 v[116:117], v[116:117], v[118:119], v[118:119]
    v_pk_fma_f32 v[120:121], v[120:121], v[122:123], v[122:123]
    v_pk_mul_f32 v[124:125], v[92:93], v[112:113]
    v_pk_mul_f32 v[126:127], v[100:101], v[120:121]
    v_pk_mul_f32 v[128:129], v[108:109], v[112:113]
    v_pk_mul_f32 v[130:131], v[116:117], v[120:121]
    v_pk_fma_f32 v[124:125], v[96:97], v[108:109], v[124:125]
    v_pk_fma_f32 v[126:127], v[104:105], v[116:117], v[126:127]
    v_pk_mul_f32 v[124:125], v[124:125], v[130:131]
    v_pk_mul_f32 v[126:127], v[126:127], v[128:129]
    s_sub_u32 s54, s54, 1
    v_pk_mul_f32 v[128:129], v[128:129], v[130:131]
    s_cbranch_scc0 k2_loop1
k2_drain:
    s_setprio 0
    s_waitcnt lgkmcnt(0)
    ds_read_b32 v104, v227
    v_max3_f32 v228, v228, v128, v129
    v_mfma_f32_32x32x8_bf16 v[44:59], v[156:157], v[164:165], v[44:59]
    s_cmp_lg_u32 s39, 0
    s_cbranch_scc1 kf_dr4
    v_mov_b32 v130, v128
    v_mov_b32 v131, v129
kf_dr4:
    v_rcp_f32 v128, v128
    v_rcp_f32 v129, v129
    v_rcp_f32 v130, v130
    v_rcp_f32 v131, v131
    s_nop 0
    v_mul_f32 v124, v124, v128
    v_mul_f32 v125, v125, v129
    v_mul_f32 v126, v126, v130
    v_mul_f32 v127, v127, v131
    v_cvt_pk_bf16_f32 v160, v124, v125
    v_cvt_pk_bf16_f32 v161, v126, v127
    s_nop 1
    v_mfma_f32_32x32x8_bf16 v[60:75], v[160:161], v[164:165], v[60:75]
k2_loopend:
    s_cmp_eq_u32 s47, 0
    s_cbranch_scc1 k2_epi
    s_add_u32 s48, s48, 1
k2_fetch:
    s_waitcnt vmcnt(0) lgkmcnt(0)
    s_barrier
    s_cmp_ge_u32 s48, s47
    s_cbranch_scc1 k2_epi
    s_lshl_b32 s55, s0, 2
    buffer_load_dword v164, v2, s[32:35], s55 offen sc1
    v_and_b32 v181, 1, v0
    s_lshl_b32 s55, s48, 1
    v_add_u32 v181, s55, v181
    s_waitcnt vmcnt(0)
    v_and_b32 v180, 0xffff, v164
    v_lshrrev_b32 v164, 16, v164
    v_add_u32 v180, v180, v181
    v_cmp_lt_u32 s[4:5], v181, v164
    v_mad_u32_u24 v180, v180, 12, v2
    buffer_load_dwordx3 v[92:94], v180, s[32:35], 0 offen offset:1024 sc1
    s_mov_b64 s[6:7], 0
    s_mov_b64 s[8:9], 0
    s_mov_b64 s[10:11], 0
    s_mov_b64 s[12:13], 0
    s_mov_b64 s[14:15], 0
    s_mov_b64 s[16:17], 0
    s_mov_b64 s[18:19], 0
    s_mov_b64 s[28:29], 0
    s_waitcnt vmcnt(0)
    s_branch k2_batch
k2_redo:
    s_mov_b32 s39, 1
    s_mov_b32 s38, 0
    s_mov_b32 s48, 0
k2_hentry:
    s_waitcnt vmcnt(0) lgkmcnt(0)
    s_lshl_b32 s55, s0, 2
    buffer_load_dword v164, v2, s[32:35], s55 offen sc1
    v_mov_b32 v180, 163776
    v_mov_b32 v181, 1
    ds_write_b32 v180, v181
    s_waitcnt vmcnt(0) lgkmcnt(0)
    s_barrier
    v_lshrrev_b32 v164, 16, v164
    v_add_u32 v164, 1, v164
    v_lshrrev_b32 v164, 1, v164
    ds_max_u32 v180, v164
    s_waitcnt lgkmcnt(0)
    s_barrier
    ds_read_b32 v181, v180
    s_waitcnt lgkmcnt(0)
    v_readfirstlane_b32 s47, v181
    s_branch k2_fetch
k2_epi:
    s_mul_i32 s55, s51, 171
    s_lshr_b32 s55, s55, 9
    s_mul_i32 s55, s55, 3
    s_sub_u32 s55, s51, s55
    s_lshl_b32 s55, s55, 12
    s_add_u32 s56, s55, s53
    v_add_u32 v76, s56, v3
    s_add_u32 s55, s55, 4096
    s_cmp_eq_u32 s55, 12288
    s_cselect_b32 s55, 0, s55
    s_add_u32 s56, s55, s53
    v_add_u32 v77, s56, v3
    s_add_u32 s55, s55, 4096
    s_cmp_eq_u32 s55, 12288
    s_cselect_b32 s55, 0, s55
    s_add_u32 s56, s55, s53
    v_add_u32 v78, s56, v3
    s_waitcnt vmcnt(4) lgkmcnt(0)
    ds_read_b128 v[156:159], v76 offset:0
    ds_read_b128 v[160:163], v76 offset:1024
    ds_read_b128 v[164:167], v76 offset:2048
    ds_read_b128 v[168:171], v76 offset:3072
    ds_read_b128 v[172:175], v77 offset:0
    ds_read_b128 v[176:179], v77 offset:1024
    ds_read_b128 v[180:183], v77 offset:2048
    ds_read_b128 v[184:187], v77 offset:3072
    s_cmp_lg_u32 s39, 0
    s_cbranch_scc1 kf_noflag
    v_cmp_lt_f32 vcc, 0x5d800000, v228
    s_cbranch_vccz kf_noflag
    v_mov_b32 v105, 1
    ds_write_b32 v227, v105 offset:4
    kf_noflag:
    s_cmp_lg_u32 s38, 0
    s_cbranch_scc1 kf_accok
    v_mov_b32 v44, 0
    v_mov_b32 v45, 0
    v_mov_b32 v46, 0
    v_mov_b32 v47, 0
    v_mov_b32 v48, 0
    v_mov_b32 v49, 0
    v_mov_b32 v50, 0
    v_mov_b32 v51, 0
    v_mov_b32 v52, 0
    v_mov_b32 v53, 0
    v_mov_b32 v54, 0
    v_mov_b32 v55, 0
    v_mov_b32 v56, 0
    v_mov_b32 v57, 0
    v_mov_b32 v58, 0
    v_mov_b32 v59, 0
    v_mov_b32 v60, 0
    v_mov_b32 v61, 0
    v_mov_b32 v62, 0
    v_mov_b32 v63, 0
    v_mov_b32 v64, 0
    v_mov_b32 v65, 0
    v_mov_b32 v66, 0
    v_mov_b32 v67, 0
    v_mov_b32 v68, 0
    v_mov_b32 v69, 0
    v_mov_b32 v70, 0
    v_mov_b32 v71, 0
    v_mov_b32 v72, 0
    v_mov_b32 v73, 0
    v_mov_b32 v74, 0
    v_mov_b32 v75, 0
kf_rspin:
    ds_read_b32 v104, v227
    s_waitcnt lgkmcnt(0)
kf_accok:
    v_readfirstlane_b32 s55, v104
    s_cmp_lt_u32 s55, 8
    s_cbranch_scc1 kf_rspin
    s_mov_b64 exec, s[36:37]
    s_cmp_eq_u32 s39, 0
    s_cbranch_scc1 kf_noscale
    v_pk_mul_f32 v[44:45], v[44:45], s[58:59]
    v_pk_mul_f32 v[46:47], v[46:47], s[58:59]
    v_pk_mul_f32 v[48:49], v[48:49], s[58:59]
    v_pk_mul_f32 v[50:51], v[50:51], s[58:59]
    v_pk_mul_f32 v[52:53], v[52:53], s[58:59]
    v_pk_mul_f32 v[54:55], v[54:55], s[58:59]
    v_pk_mul_f32 v[56:57], v[56:57], s[58:59]
    v_pk_mul_f32 v[58:59], v[58:59], s[58:59]
    v_pk_mul_f32 v[60:61], v[60:61], s[58:59]
    v_pk_mul_f32 v[62:63], v[62:63], s[58:59]
    v_pk_mul_f32 v[64:65], v[64:65], s[58:59]
    v_pk_mul_f32 v[66:67], v[66:67], s[58:59]
    v_pk_mul_f32 v[68:69], v[68:69], s[58:59]
    v_pk_mul_f32 v[70:71], v[70:71], s[58:59]
    v_pk_mul_f32 v[72:73], v[72:73], s[58:59]
    v_pk_mul_f32 v[74:75], v[74:75], s[58:59]
kf_noscale:
    v_cvt_pk_bf16_f32 v44, v44, v45
    v_cvt_pk_bf16_f32 v45, v46, v47
    ds_write_b64 v224, v[44:45]
    v_xor_b32 v107, 16, v224
    v_cvt_pk_bf16_f32 v48, v48, v49
    v_cvt_pk_bf16_f32 v49, v50, v51
    ds_write_b64 v107, v[48:49]
    v_xor_b32 v107, 32, v224
    v_cvt_pk_bf16_f32 v52, v52, v53
    v_cvt_pk_bf16_f32 v53, v54, v55
    ds_write_b64 v107, v[52:53]
    v_xor_b32 v107, 48, v224
    v_cvt_pk_bf16_f32 v56, v56, v57
    v_cvt_pk_bf16_f32 v57, v58, v59
    ds_write_b64 v107, v[56:57]
    v_xor_b32 v107, 64, v224
    v_cvt_pk_bf16_f32 v60, v60, v61
    v_cvt_pk_bf16_f32 v61, v62, v63
    ds_write_b64 v107, v[60:61]
    v_xor_b32 v107, 80, v224
    v_cvt_pk_bf16_f32 v64, v64, v65
    v_cvt_pk_bf16_f32 v65, v66, v67
    ds_write_b64 v107, v[64:65]
    v_xor_b32 v107, 96, v224
    v_cvt_pk_bf16_f32 v68, v68, v69
    v_cvt_pk_bf16_f32 v69, v70, v71
    ds_write_b64 v107, v[68:69]
    v_xor_b32 v107, 112, v224
    v_cvt_pk_bf16_f32 v72, v72, v73
    v_cvt_pk_bf16_f32 v73, v74, v75
    ds_write_b64 v107, v[72:73]
    s_mov_b64 exec, -1
    s_waitcnt vmcnt(0)
    ds_read_b128 v[188:191], v78 offset:0
    ds_read_b128 v[192:195], v78 offset:1024
    ds_read_b128 v[196:199], v78 offset:2048
    ds_read_b128 v[200:203], v78 offset:3072
    s_lshl_b32 s56, s98, 9
    s_lshl_b32 s55, s44, 6
    s_add_u32 s56, s56, s55
    s_waitcnt lgkmcnt(0)
    s_barrier
    ds_read_b32 v104, v227 offset:4
    ds_read_b128 v[132:135], v220 offset:0
    ds_read_b128 v[136:139], v221 offset:0
    ds_read_b128 v[140:143], v222 offset:0
    ds_read_b128 v[144:147], v223 offset:0
    ds_read_b128 v[148:151], v220 offset:256
    s_waitcnt lgkmcnt(5)
    v_readfirstlane_b32 s55, v104
    s_cmp_gt_u32 s55, s39
    s_cbranch_scc1 k2_redo
    s_mov_b32 s58, 0xbfb8aa3b
    ds_read_b128 v[152:155], v221 offset:256
    s_waitcnt lgkmcnt(5)
    v_mfma_f32_16x16x32_bf16 v[232:235], v[156:159], v[132:135], v[232:235]
    v_mfma_f32_16x16x32_bf16 v[236:239], v[160:163], v[132:135], v[236:239]
    ds_read_b128 v[132:135], v222 offset:256
    s_waitcnt lgkmcnt(5)
    v_mfma_f32_16x16x32_bf16 v[232:235], v[164:167], v[136:139], v[232:235]
    v_mfma_f32_16x16x32_bf16 v[236:239], v[168:171], v[136:139], v[236:239]
    ds_read_b128 v[136:139], v223 offset:256
    s_waitcnt lgkmcnt(5)
    v_mfma_f32_16x16x32_bf16 v[232:235], v[172:175], v[140:143], v[232:235]
    v_mfma_f32_16x16x32_bf16 v[236:239], v[176:179], v[140:143], v[236:239]
    ds_read_b128 v[140:143], v220 offset:8192
    s_waitcnt lgkmcnt(5)
    v_mfma_f32_16x16x32_bf16 v[232:235], v[180:183], v[144:147], v[232:235]
    v_mfma_f32_16x16x32_bf16 v[236:239], v[184:187], v[144:147], v[236:239]
    ds_read_b128 v[144:147], v221 offset:8192
    s_waitcnt lgkmcnt(5)
    v_mfma_f32_16x16x32_bf16 v[232:235], v[188:191], v[148:151], v[232:235]
    v_mfma_f32_16x16x32_bf16 v[236:239], v[192:195], v[148:151], v[236:239]
    ds_read_b128 v[148:151], v222 offset:8192
    s_waitcnt lgkmcnt(5)
    v_mfma_f32_16x16x32_bf16 v[232:235], v[196:199], v[152:155], v[232:235]
    v_mfma_f32_16x16x32_bf16 v[236:239], v[200:203], v[152:155], v[236:239]
    ds_read_b128 v[152:155], v223 offset:8192
    s_waitcnt lgkmcnt(5)
    v_mfma_f32_16x16x32_bf16 v[232:235], v[204:207], v[132:135], v[232:235]
    v_mfma_f32_16x16x32_bf16 v[236:239], v[208:211], v[132:135], v[236:239]
    ds_read_b128 v[132:135], v220 offset:8448
    s_waitcnt lgkmcnt(5)
    v_mfma_f32_16x16x32_bf16 v[232:235], v[212:215], v[136:139], v[232:235]
    v_mfma_f32_16x16x32_bf16 v[236:239], v[216:219], v[136:139], v[236:239]
    ds_read_b128 v[136:139], v221 offset:8448
    s_waitcnt lgkmcnt(5)
    v_mfma_f32_16x16x32_bf16 v[240:243], v[156:159], v[140:143], v[240:243]
    v_mfma_f32_16x16x32_bf16 v[244:247], v[160:163], v[140:143], v[244:247]
    ds_read_b128 v[140:143], v222 offset:8448
    s_waitcnt lgkmcnt(5)
    v_mfma_f32_16x16x32_bf16 v[240:243], v[164:167], v[144:147], v[240:243]
    v_exp_f32 v76, v232
    v_exp_f32 v77, v233
    v_exp_f32 v78, v234
    v_mfma_f32_16x16x32_bf16 v[244:247], v[168:171], v[144:147], v[244:247]
    v_exp_f32 v79, v235
    v_exp_f32 v80, v236
    v_exp_f32 v81, v237
    ds_read_b128 v[144:147], v223 offset:8448
    s_waitcnt lgkmcnt(5)
    v_mfma_f32_16x16x32_bf16 v[240:243], v[172:175], v[148:151], v[240:243]
    v_exp_f32 v82, v238
    v_exp_f32 v83, v239
    v_fma_f32 v76, v76, s58, s58
    v_mfma_f32_16x16x32_bf16 v[244:247], v[176:179], v[148:151], v[244:247]
    v_fma_f32 v77, v77, s58, s58
    v_fma_f32 v78, v78, s58, s58
    v_fma_f32 v79, v79, s58, s58
    ds_read_b128 v[148:151], v220 offset:16384
    s_waitcnt lgkmcnt(5)
    v_mfma_f32_16x16x32_bf16 v[240:243], v[180:183], v[152:155], v[240:243]
    v_fma_f32 v80, v80, s58, s58
    v_fma_f32 v81, v81, s58, s58
    v_fma_f32 v82, v82, s58, s58
    v_mfma_f32_16x16x32_bf16 v[244:247], v[184:187], v[152:155], v[244:247]
    v_fma_f32 v83, v83, s58, s58
    v_rcp_f32 v76, v76
    v_rcp_f32 v77, v77
    ds_read_b128 v[152:155], v221 offset:16384
    s_waitcnt lgkmcnt(5)
    v_mfma_f32_16x16x32_bf16 v[240:243], v[188:191], v[132:135], v[240:243]
    v_rcp_f32 v78, v78
    v_rcp_f32 v79, v79
    v_rcp_f32 v80, v80
    v_mfma_f32_16x16x32_bf16 v[244:247], v[192:195], v[132:135], v[244:247]
    v_rcp_f32 v81, v81
    v_rcp_f32 v82, v82
    v_rcp_f32 v83, v83
    ds_read_b128 v[132:135], v222 offset:16384
    s_waitcnt lgkmcnt(5)
    v_mfma_f32_16x16x32_bf16 v[240:243], v[196:199], v[136:139], v[240:243]
    v_mul_f32 v76, v232, v76
    v_mul_f32 v77, v233, v77
    v_mul_f32 v78, v234, v78
    v_mfma_f32_16x16x32_bf16 v[244:247], v[200:203], v[136:139], v[244:247]
    v_mul_f32 v79, v235, v79
    v_mul_f32 v80, v236, v80
    v_mul_f32 v81, v237, v81
    ds_read_b128 v[136:139], v223 offset:16384
    s_waitcnt lgkmcnt(5)
    v_mfma_f32_16x16x32_bf16 v[240:243], v[204:207], v[140:143], v[240:243]
    v_mul_f32 v82, v238, v82
    v_mul_f32 v83, v239, v83
    v_cvt_pk_bf16_f32 v84, v76, v77
    v_mfma_f32_16x16x32_bf16 v[244:247], v[208:211], v[140:143], v[244:247]
    v_cvt_pk_bf16_f32 v85, v78, v79
    v_cvt_pk_bf16_f32 v86, v80, v81
    v_cvt_pk_bf16_f32 v87, v82, v83
    ds_read_b128 v[140:143], v220 offset:16640
    s_waitcnt lgkmcnt(5)
    v_mfma_f32_16x16x32_bf16 v[240:243], v[212:215], v[144:147], v[240:243]
    buffer_store_dwordx4 v[84:87], v226, s[24:27], s56 offen sc1
    s_add_u32 s56, s56, 8192
    v_mfma_f32_16x16x32_bf16 v[244:247], v[216:219], v[144:147], v[244:247]
    ds_read_b128 v[144:147], v221 offset:16640
    s_waitcnt lgkmcnt(5)
    v_mfma_f32_16x16x32_bf16 v[248:251], v[156:159], v[148:151], v[248:251]
    v_mfma_f32_16x16x32_bf16 v[252:255], v[160:163], v[148:151], v[252:255]
    ds_read_b128 v[148:151], v222 offset:16640
    s_waitcnt lgkmcnt(5)
    v_mfma_f32_16x16x32_bf16 v[248:251], v[164:167], v[152:155], v[248:251]
    v_exp_f32 v76, v240
    v_exp_f32 v77, v241
    v_exp_f32 v78, v242
    v_mfma_f32_16x16x32_bf16 v[252:255], v[168:171], v[152:155], v[252:255]
    v_exp_f32 v79, v243
    v_exp_f32 v80, v244
    v_exp_f32 v81, v245
    ds_read_b128 v[152:155], v223 offset:16640
    s_waitcnt lgkmcnt(5)
    v_mfma_f32_16x16x32_bf16 v[248:251], v[172:175], v[132:135], v[248:251]
    v_exp_f32 v82, v246
    v_exp_f32 v83, v247
    v_fma_f32 v76, v76, s58, s58
    v_mfma_f32_16x16x32_bf16 v[252:255], v[176:179], v[132:135], v[252:255]
    v_fma_f32 v77, v77, s58, s58
    v_fma_f32 v78, v78, s58, s58
    v_fma_f32 v79, v79, s58, s58
    s_waitcnt lgkmcnt(4)
    v_mfma_f32_16x16x32_bf16 v[248:251], v[180:183], v[136:139], v[248:251]
    v_fma_f32 v80, v80, s58, s58
    v_fma_f32 v81, v81, s58, s58
    v_fma_f32 v82, v82, s58, s58
    v_mfma_f32_16x16x32_bf16 v[252:255], v[184:187], v[136:139], v[252:255]
    v_fma_f32 v83, v83, s58, s58
    v_rcp_f32 v76, v76
    v_rcp_f32 v77, v77
    s_waitcnt lgkmcnt(3)
    v_mfma_f32_16x16x32_bf16 v[248:251], v[188:191], v[140:143], v[248:251]
    v_rcp_f32 v78, v78
    v_rcp_f32 v79, v79
    v_rcp_f32 v80, v80
    v_mfma_f32_16x16x32_bf16 v[252:255], v[192:195], v[140:143], v[252:255]
    v_rcp_f32 v81, v81
    v_rcp_f32 v82, v82
    v_rcp_f32 v83, v83
    s_waitcnt lgkmcnt(2)
    v_mfma_f32_16x16x32_bf16 v[248:251], v[196:199], v[144:147], v[248:251]
    v_mul_f32 v76, v240, v76
    v_mul_f32 v77, v241, v77
    v_mul_f32 v78, v242, v78
    v_mfma_f32_16x16x32_bf16 v[252:255], v[200:203], v[144:147], v[252:255]
    v_mul_f32 v79, v243, v79
    v_mul_f32 v80, v244, v80
    v_mul_f32 v81, v245, v81
    s_waitcnt lgkmcnt(1)
    v_mfma_f32_16x16x32_bf16 v[248:251], v[204:207], v[148:151], v[248:251]
    v_mul_f32 v82, v246, v82
    v_mul_f32 v83, v247, v83
    v_cvt_pk_bf16_f32 v84, v76, v77
    v_mfma_f32_16x16x32_bf16 v[252:255], v[208:211], v[148:151], v[252:255]
    v_cvt_pk_bf16_f32 v85, v78, v79
    v_cvt_pk_bf16_f32 v86, v80, v81
    v_cvt_pk_bf16_f32 v87, v82, v83
    s_waitcnt lgkmcnt(0)
    v_mfma_f32_16x16x32_bf16 v[248:251], v[212:215], v[152:155], v[248:251]
    buffer_store_dwordx4 v[84:87], v226, s[24:27], s56 offen sc1
    s_add_u32 s56, s56, 8192
    v_mfma_f32_16x16x32_bf16 v[252:255], v[216:219], v[152:155], v[252:255]
    s_mov_b32 s59, 0xbfb8aa3b
    s_sub_u32 s55, s3, 32
    s_bfm_b32 s57, s55, 0
    s_mul_i32 s57, s57, 0x10001
    s_nop 3
    v_mov_b32_dpp v248, v252 row_shr:8 row_mask:0xf bank_mask:0xc
    v_mov_b32_dpp v249, v253 row_shr:8 row_mask:0xf bank_mask:0xc
    v_mov_b32_dpp v250, v254 row_shr:8 row_mask:0xf bank_mask:0xc
    v_mov_b32_dpp v251, v255 row_shr:8 row_mask:0xf bank_mask:0xc
    v_exp_f32 v76, v248
    v_exp_f32 v77, v249
    v_exp_f32 v78, v250
    v_exp_f32 v79, v251
    v_pk_fma_f32 v[76:77], v[76:77], s[58:59], s[58:59]
    v_pk_fma_f32 v[78:79], v[78:79], s[58:59], s[58:59]
    v_rcp_f32 v76, v76
    v_rcp_f32 v77, v77
    v_rcp_f32 v78, v78
    v_rcp_f32 v79, v79
    v_pk_mul_f32 v[76:77], v[248:249], v[76:77]
    v_pk_mul_f32 v[78:79], v[250:251], v[78:79]
    s_nop 1
    v_mov_b32_dpp v80, v76 row_shl:8 row_mask:0xf bank_mask:0x3
    v_mov_b32_dpp v81, v77 row_shl:8 row_mask:0xf bank_mask:0x3
    v_mov_b32_dpp v82, v78 row_shl:8 row_mask:0xf bank_mask:0x3
    v_mov_b32_dpp v83, v79 row_shl:8 row_mask:0xf bank_mask:0x3
    v_cvt_pk_bf16_f32 v84, v76, v77
    v_cvt_pk_bf16_f32 v85, v78, v79
    v_cvt_pk_bf16_f32 v86, v80, v81
    v_cvt_pk_bf16_f32 v87, v82, v83
    s_mov_b32 exec_lo, s57
    s_mov_b32 exec_hi, s57
    buffer_store_dwordx4 v[84:87], v226, s[24:27], s56 offen sc1
    s_add_u32 s56, s56, 8192
k2_done:
    s_endpgm
k2_drain1:
    s_setprio 0
    s_waitcnt lgkmcnt(0)
    ds_read_b32 v104, v227
    v_max3_f32 v228, v228, v128, v129
    v_mfma_f32_32x32x16_bf16 v[44:59], v[156:159], v[164:167], v[44:59]
    s_cmp_lg_u32 s39, 0
    s_cbranch_scc1 kf_dr41
    v_mov_b32 v130, v128
    v_mov_b32 v131, v129
kf_dr41:
    v_rcp_f32 v128, v128
    v_rcp_f32 v129, v129
    v_rcp_f32 v130, v130
    v_rcp_f32 v131, v131
    s_nop 0
    v_mul_f32 v124, v124, v128
    v_mul_f32 v125, v125, v129
    v_mul_f32 v126, v126, v130
    v_mul_f32 v127, v127, v131
    v_cvt_pk_bf16_f32 v162, v124, v125
    v_cvt_pk_bf16_f32 v163, v126, v127
    s_nop 1
    v_mfma_f32_32x32x16_bf16 v[60:75], v[160:163], v[164:167], v[60:75]
    s_branch k2_loopend
k2_notile:
    ds_read_u16 v184, v4 offset:128
    ds_read_u16 v186, v4 offset:132
    ds_read_u16 v188, v4 offset:144
    ds_read_u16 v190, v4 offset:148
    s_add_u32 m0, s53, 8192
    s_waitcnt lgkmcnt(0)
    buffer_load_dwordx4 v[184:185], s[20:23], 0 idxen offen offset:0 lds
    buffer_load_dwordx4 v[186:187], s[20:23], 0 idxen offen offset:1024 lds
    buffer_load_dwordx4 v[188:189], s[20:23], 0 idxen offen offset:2048 lds
    buffer_load_dwordx4 v[190:191], s[20:23], 0 idxen offen offset:3072 lds
    s_branch k2_loopend
kf_init:
    s_add_u32 s60, s32, 8257536
    s_addc_u32 s61, s33, 0
    s_and_b32 s61, s61, 0xffff
    s_mov_b32 s62, 16384
    s_mov_b32 s63, 0x20000
    v_mov_b32 v124, 0
    v_mov_b32 v125, 0
    v_mov_b32 v126, 0
    v_mov_b32 v127, 0
    s_mov_b32 s56, 8192
    buffer_store_dwordx4 v[124:127], v111, s[60:63], 0 offen sc1
    buffer_store_dwordx4 v[124:127], v111, s[60:63], s56 offen sc1
    s_branch kf_noinit
k2_safe:
    s_waitcnt lgkmcnt(0)
    s_cmp_lg_u32 s38, 0
    s_cbranch_scc1 kf_fSA_a
    v_mfma_f32_32x32x8_bf16 v[44:59], v[156:157], v[164:165], 0
kf_fSA_a:
    v_exp_f32 v108, v76
    v_exp_f32 v109, v77
    v_exp_f32 v110, v78
    v_exp_f32 v111, v79
    v_exp_f32 v112, v80
    v_mfma_f32_32x32x16_bf16 v[92:107], v[26:29], v[34:37], 0
    v_exp_f32 v113, v81
    v_exp_f32 v114, v82
    v_exp_f32 v115, v83
    v_exp_f32 v116, v84
    v_exp_f32 v117, v85
    v_mfma_f32_32x32x16_bf16 v[92:107], v[140:143], v[148:151], v[92:107]
    v_exp_f32 v118, v86
    v_exp_f32 v119, v87
    v_exp_f32 v120, v88
    v_exp_f32 v121, v89
    v_exp_f32 v122, v90
    v_mfma_f32_32x32x16_bf16 v[92:107], v[144:147], v[152:155], v[92:107]
    v_mad_u32_u24 v10, v9, s68, v7
    v_add_u32 v12, s69, v10
    v_exp_f32 v123, v91
    v_rcp_f32 v128, v128
    v_rcp_f32 v129, v129
    v_rcp_f32 v130, v130
    v_rcp_f32 v131, v131
    v_pk_fma_f32 v[108:109], v[108:109], s[58:59], s[58:59] clamp
    s_waitcnt vmcnt(4)
    v_pk_fma_f32 v[110:111], v[110:111], s[58:59], s[58:59] clamp
    ds_read_b128 v[132:135], v14 offset:4096
    v_pk_fma_f32 v[112:113], v[112:113], s[58:59], s[58:59] clamp
    ds_read_b128 v[136:139], v15 offset:4096
    v_pk_fma_f32 v[114:115], v[114:115], s[58:59], s[58:59] clamp
    ds_read_b64_tr_b16 v[32:33], v10
    v_pk_fma_f32 v[116:117], v[116:117], s[58:59], s[58:59] clamp
    ds_read_b128 v[26:29], v5 offset:512
    v_pk_fma_f32 v[118:119], v[118:119], s[58:59], s[58:59] clamp
    s_add_u32 m0, s53, 8192
    v_pk_fma_f32 v[120:121], v[120:121], s[58:59], s[58:59] clamp
    buffer_load_dwordx4 v[184:185], s[20:23], 0 idxen offen offset:0 lds
    v_pk_fma_f32 v[122:123], v[122:123], s[58:59], s[58:59] clamp
    v_pk_mul_f32 v[124:125], v[124:125], v[128:129]
    v_pk_mul_f32 v[126:127], v[126:127], v[130:131]
    buffer_load_dwordx4 v[186:187], s[20:23], 0 idxen offen offset:1024 lds
    v_pk_mul_f32 v[76:77], v[76:77], v[110:111]
    v_pk_mul_f32 v[80:81], v[80:81], v[114:115]
    v_pk_mul_f32 v[84:85], v[84:85], v[118:119]
    buffer_load_dwordx4 v[188:189], s[20:23], 0 idxen offen offset:2048 lds
    v_pk_mul_f32 v[88:89], v[88:89], v[122:123]
    v_cvt_pk_bf16_f32 v160, v124, v125
    v_cvt_pk_bf16_f32 v161, v126, v127
    buffer_load_dwordx4 v[190:191], s[20:23], 0 idxen offen offset:3072 lds
    v_pk_fma_f32 v[76:77], v[78:79], v[108:109], v[76:77]
    v_pk_fma_f32 v[80:81], v[82:83], v[112:113], v[80:81]
    s_mov_b32 m0, s53
    v_pk_fma_f32 v[84:85], v[86:87], v[116:117], v[84:85]
    buffer_load_dwordx4 v[18:19], s[20:23], 0 idxen offen offset:0 lds
    v_pk_fma_f32 v[88:89], v[90:91], v[120:121], v[88:89]
    v_pk_mul_f32 v[108:109], v[108:109], v[110:111]
    v_pk_mul_f32 v[112:113], v[112:113], v[114:115]
    buffer_load_dwordx4 v[20:21], s[20:23], 0 idxen offen offset:1024 lds
    v_pk_mul_f32 v[116:117], v[116:117], v[118:119]
    v_pk_mul_f32 v[120:121], v[120:121], v[122:123]
    v_pk_mul_f32 v[124:125], v[76:77], v[112:113]
    buffer_load_dwordx4 v[22:23], s[20:23], 0 idxen offen offset:2048 lds
    v_pk_mul_f32 v[126:127], v[84:85], v[120:121]
    v_pk_mul_f32 v[128:129], v[108:109], v[112:113]
    v_pk_mul_f32 v[130:131], v[116:117], v[120:121]
    buffer_load_dwordx4 v[24:25], s[20:23], 0 idxen offen offset:3072 lds
    v_pk_fma_f32 v[124:125], v[80:81], v[108:109], v[124:125]
    v_pk_fma_f32 v[126:127], v[88:89], v[116:117], v[126:127]
    s_waitcnt lgkmcnt(0)
    s_cmp_lg_u32 s38, 0
    s_cbranch_scc1 kf_fSB_a
    v_mfma_f32_32x32x8_bf16 v[60:75], v[160:161], v[164:165], 0
kf_fSB_a:
    v_exp_f32 v108, v92
    v_exp_f32 v109, v93
    v_exp_f32 v110, v94
    v_exp_f32 v111, v95
    v_exp_f32 v112, v96
    v_mfma_f32_32x32x16_bf16 v[76:91], v[26:29], v[30:33], 0
    v_exp_f32 v113, v97
    v_exp_f32 v114, v98
    v_exp_f32 v115, v99
    v_exp_f32 v116, v100
    v_exp_f32 v117, v101
    v_mfma_f32_32x32x16_bf16 v[76:91], v[132:135], v[148:151], v[76:91]
    v_exp_f32 v118, v102
    v_exp_f32 v119, v103
    v_exp_f32 v120, v104
    v_exp_f32 v121, v105
    v_exp_f32 v122, v106
    v_mfma_f32_32x32x16_bf16 v[76:91], v[136:139], v[152:155], v[76:91]
    v_exp_f32 v123, v107
    v_rcp_f32 v128, v128
    v_rcp_f32 v129, v129
    v_rcp_f32 v130, v130
    v_rcp_f32 v131, v131
    v_pk_fma_f32 v[108:109], v[108:109], s[58:59], s[58:59] clamp
    ds_read_b128 v[140:143], v16 offset:4096
    v_pk_fma_f32 v[110:111], v[110:111], s[58:59], s[58:59] clamp
    v_pk_fma_f32 v[112:113], v[112:113], s[58:59], s[58:59] clamp
    ds_read_b128 v[144:147], v17 offset:4096
    v_pk_fma_f32 v[114:115], v[114:115], s[58:59], s[58:59] clamp
    v_pk_fma_f32 v[116:117], v[116:117], s[58:59], s[58:59] clamp
    ds_read_b64_tr_b16 v[36:37], v10 offset:64
    v_pk_fma_f32 v[118:119], v[118:119], s[58:59], s[58:59] clamp
    v_pk_fma_f32 v[120:121], v[120:121], s[58:59], s[58:59] clamp
    ds_read_b64_tr_b16 v[164:165], v11
    v_pk_fma_f32 v[122:123], v[122:123], s[58:59], s[58:59] clamp
    v_pk_mul_f32 v[124:125], v[124:125], v[128:129]
    ds_read_u8 v9, v6 offset:16
    v_pk_mul_f32 v[126:127], v[126:127], v[130:131]
    v_pk_mul_f32 v[92:93], v[92:93], v[110:111]
    ds_read_u16 v18, v4 offset:256
    v_pk_mul_f32 v[96:97], v[96:97], v[114:115]
    v_pk_mul_f32 v[100:101], v[100:101], v[118:119]
    ds_read_u16 v20, v4 offset:260
    v_pk_mul_f32 v[104:105], v[104:105], v[122:123]
    v_cvt_pk_bf16_f32 v156, v124, v125
    ds_read_u16 v22, v4 offset:272
    v_cvt_pk_bf16_f32 v157, v126, v127
    v_pk_fma_f32 v[92:93], v[94:95], v[108:109], v[92:93]
    ds_read_u16 v24, v4 offset:276
    v_pk_fma_f32 v[96:97], v[98:99], v[112:113], v[96:97]
    v_pk_fma_f32 v[100:101], v[102:103], v[116:117], v[100:101]
    v_pk_fma_f32 v[104:105], v[106:107], v[120:121], v[104:105]
    v_pk_mul_f32 v[108:109], v[108:109], v[110:111]
    v_pk_mul_f32 v[112:113], v[112:113], v[114:115]
    v_pk_mul_f32 v[116:117], v[116:117], v[118:119]
    v_pk_mul_f32 v[120:121], v[120:121], v[122:123]
    v_pk_mul_f32 v[124:125], v[92:93], v[112:113]
    v_pk_mul_f32 v[126:127], v[100:101], v[120:121]
    v_pk_mul_f32 v[128:129], v[108:109], v[112:113]
    s_mov_b32 s38, 1
    v_pk_mul_f32 v[130:131], v[116:117], v[120:121]
    v_pk_fma_f32 v[124:125], v[96:97], v[108:109], v[124:125]
    s_sub_u32 s54, s54, 1
    v_pk_fma_f32 v[126:127], v[104:105], v[116:117], v[126:127]
    s_cbranch_scc1 k2_drain
k2_loopS:
    s_waitcnt lgkmcnt(0)
    v_mfma_f32_32x32x8_bf16 v[44:59], v[156:157], v[164:165], v[44:59]
    v_exp_f32 v108, v76
    v_exp_f32 v109, v77
    v_exp_f32 v110, v78
    v_exp_f32 v111, v79
    v_exp_f32 v112, v80
    v_mfma_f32_32x32x16_bf16 v[92:107], v[26:29], v[34:37], 0
    v_exp_f32 v113, v81
    v_exp_f32 v114, v82
    v_exp_f32 v115, v83
    v_exp_f32 v116, v84
    v_exp_f32 v117, v85
    v_mfma_f32_32x32x16_bf16 v[92:107], v[140:143], v[148:151], v[92:107]
    v_exp_f32 v118, v86
    v_exp_f32 v119, v87
    v_exp_f32 v120, v88
    v_exp_f32 v121, v89
    v_exp_f32 v122, v90
    v_mfma_f32_32x32x16_bf16 v[92:107], v[144:147], v[152:155], v[92:107]
    v_mad_u32_u24 v10, v9, s68, v7
    v_add_u32 v13, s69, v10
    v_exp_f32 v123, v91
    v_rcp_f32 v128, v128
    v_rcp_f32 v129, v129
    v_rcp_f32 v130, v130
    v_rcp_f32 v131, v131
    v_pk_fma_f32 v[108:109], v[108:109], s[58:59], s[58:59] clamp
    s_waitcnt vmcnt(4)
    v_pk_fma_f32 v[110:111], v[110:111], s[58:59], s[58:59] clamp
    ds_read_b128 v[132:135], v14 offset:8192
    v_pk_fma_f32 v[112:113], v[112:113], s[58:59], s[58:59] clamp
    ds_read_b128 v[136:139], v15 offset:8192
    v_pk_fma_f32 v[114:115], v[114:115], s[58:59], s[58:59] clamp
    ds_read_b64_tr_b16 v[32:33], v10
    v_pk_fma_f32 v[116:117], v[116:117], s[58:59], s[58:59] clamp
    ds_read_b128 v[26:29], v5 offset:1024
    v_pk_fma_f32 v[118:119], v[118:119], s[58:59], s[58:59] clamp
    s_add_u32 m0, s53, 4096
    v_pk_fma_f32 v[120:121], v[120:121], s[58:59], s[58:59] clamp
    v_pk_fma_f32 v[122:123], v[122:123], s[58:59], s[58:59] clamp
    buffer_load_dwordx4 v[18:19], s[20:23], 0 idxen offen offset:0 lds
    v_pk_mul_f32 v[124:125], v[124:125], v[128:129]
    v_pk_mul_f32 v[126:127], v[126:127], v[130:131]
    v_pk_mul_f32 v[76:77], v[76:77], v[110:111]
    v_pk_mul_f32 v[80:81], v[80:81], v[114:115]
    v_pk_mul_f32 v[84:85], v[84:85], v[118:119]
    v_pk_mul_f32 v[88:89], v[88:89], v[122:123]
    v_cvt_pk_bf16_f32 v160, v124, v125
    buffer_load_dwordx4 v[20:21], s[20:23], 0 idxen offen offset:1024 lds
    v_cvt_pk_bf16_f32 v161, v126, v127
    v_pk_fma_f32 v[76:77], v[78:79], v[108:109], v[76:77]
    v_pk_fma_f32 v[80:81], v[82:83], v[112:113], v[80:81]
    v_pk_fma_f32 v[84:85], v[86:87], v[116:117], v[84:85]
    v_pk_fma_f32 v[88:89], v[90:91], v[120:121], v[88:89]
    v_pk_mul_f32 v[108:109], v[108:109], v[110:111]
    v_pk_mul_f32 v[112:113], v[112:113], v[114:115]
    buffer_load_dwordx4 v[22:23], s[20:23], 0 idxen offen offset:2048 lds
    v_pk_mul_f32 v[116:117], v[116:117], v[118:119]
    v_pk_mul_f32 v[120:121], v[120:121], v[122:123]
    v_pk_mul_f32 v[124:125], v[76:77], v[112:113]
    v_pk_mul_f32 v[126:127], v[84:85], v[120:121]
    v_pk_mul_f32 v[128:129], v[108:109], v[112:113]
    v_pk_mul_f32 v[130:131], v[116:117], v[120:121]
    v_pk_fma_f32 v[124:125], v[80:81], v[108:109], v[124:125]
    buffer_load_dwordx4 v[24:25], s[20:23], 0 idxen offen offset:3072 lds
    v_pk_fma_f32 v[126:127], v[88:89], v[116:117], v[126:127]
    s_waitcnt lgkmcnt(0)
    v_mfma_f32_32x32x8_bf16 v[60:75], v[160:161], v[164:165], v[60:75]
    v_exp_f32 v108, v92
    v_exp_f32 v109, v93
    v_exp_f32 v110, v94
    v_exp_f32 v111, v95
    v_exp_f32 v112, v96
    v_mfma_f32_32x32x16_bf16 v[76:91], v[26:29], v[30:33], 0
    v_exp_f32 v113, v97
    v_exp_f32 v114, v98
    v_exp_f32 v115, v99
    v_exp_f32 v116, v100
    v_exp_f32 v117, v101
    v_mfma_f32_32x32x16_bf16 v[76:91], v[132:135], v[148:151], v[76:91]
    v_exp_f32 v118, v102
    v_exp_f32 v119, v103
    v_exp_f32 v120, v104
    v_exp_f32 v121, v105
    v_exp_f32 v122, v106
    v_mfma_f32_32x32x16_bf16 v[76:91], v[136:139], v[152:155], v[76:91]
    v_exp_f32 v123, v107
    v_rcp_f32 v128, v128
    v_rcp_f32 v129, v129
    v_rcp_f32 v130, v130
    v_rcp_f32 v131, v131
    v_pk_fma_f32 v[108:109], v[108:109], s[58:59], s[58:59] clamp
    ds_read_b128 v[140:143], v16 offset:8192
    v_pk_fma_f32 v[110:111], v[110:111], s[58:59], s[58:59] clamp
    v_pk_fma_f32 v[112:113], v[112:113], s[58:59], s[58:59] clamp
    ds_read_b128 v[144:147], v17 offset:8192
    v_pk_fma_f32 v[114:115], v[114:115], s[58:59], s[58:59] clamp
    v_pk_fma_f32 v[116:117], v[116:117], s[58:59], s[58:59] clamp
    ds_read_b64_tr_b16 v[36:37], v10 offset:64
    v_pk_fma_f32 v[118:119], v[118:119], s[58:59], s[58:59] clamp
    v_pk_fma_f32 v[120:121], v[120:121], s[58:59], s[58:59] clamp
    ds_read_b64_tr_b16 v[164:165], v12
    v_pk_fma_f32 v[122:123], v[122:123], s[58:59], s[58:59] clamp
    v_pk_mul_f32 v[124:125], v[124:125], v[128:129]
    ds_read_u8 v9, v6 offset:24
    v_pk_mul_f32 v[126:127], v[126:127], v[130:131]
    v_pk_mul_f32 v[92:93], v[92:93], v[110:111]
    ds_read_u16 v18, v4 offset:320
    v_pk_mul_f32 v[96:97], v[96:97], v[114:115]
    v_pk_mul_f32 v[100:101], v[100:101], v[118:119]
    ds_read_u16 v20, v4 offset:324
    v_pk_mul_f32 v[104:105], v[104:105], v[122:123]
    v_cvt_pk_bf16_f32 v156, v124, v125
    ds_read_u16 v22, v4 offset:336
    v_cvt_pk_bf16_f32 v157, v126, v127
    v_pk_fma_f32 v[92:93], v[94:95], v[108:109], v[92:93]
    ds_read_u16 v24, v4 offset:340
    v_pk_fma_f32 v[96:97], v[98:99], v[112:113], v[96:97]
    v_pk_fma_f32 v[100:101], v[102:103], v[116:117], v[100:101]
    v_pk_fma_f32 v[104:105], v[106:107], v[120:121], v[104:105]
    v_pk_mul_f32 v[108:109], v[108:109], v[110:111]
    v_pk_mul_f32 v[112:113], v[112:113], v[114:115]
    v_pk_mul_f32 v[116:117], v[116:117], v[118:119]
    v_pk_mul_f32 v[120:121], v[120:121], v[122:123]
    v_pk_mul_f32 v[124:125], v[92:93], v[112:113]
    v_pk_mul_f32 v[126:127], v[100:101], v[120:121]
    v_pk_mul_f32 v[128:129], v[108:109], v[112:113]
    v_pk_mul_f32 v[130:131], v[116:117], v[120:121]
    v_pk_fma_f32 v[124:125], v[96:97], v[108:109], v[124:125]
    s_sub_u32 s54, s54, 1
    v_pk_fma_f32 v[126:127], v[104:105], v[116:117], v[126:127]
    s_cbranch_scc1 k2_drain
    s_waitcnt lgkmcnt(0)
    v_mfma_f32_32x32x8_bf16 v[44:59], v[156:157], v[164:165], v[44:59]
    v_exp_f32 v108, v76
    v_exp_f32 v109, v77
    v_exp_f32 v110, v78
    v_exp_f32 v111, v79
    v_exp_f32 v112, v80
    v_mfma_f32_32x32x16_bf16 v[92:107], v[26:29], v[34:37], 0
    v_exp_f32 v113, v81
    v_exp_f32 v114, v82
    v_exp_f32 v115, v83
    v_exp_f32 v116, v84
    v_exp_f32 v117, v85
    v_mfma_f32_32x32x16_bf16 v[92:107], v[140:143], v[148:151], v[92:107]
    v_exp_f32 v118, v86
    v_exp_f32 v119, v87
    v_exp_f32 v120, v88
    v_exp_f32 v121, v89
    v_exp_f32 v122, v90
    v_mfma_f32_32x32x16_bf16 v[92:107], v[144:147], v[152:155], v[92:107]
    v_mad_u32_u24 v10, v9, s68, v7
    v_add_u32 v11, s69, v10
    v_exp_f32 v123, v91
    v_rcp_f32 v128, v128
    v_rcp_f32 v129, v129
    v_rcp_f32 v130, v130
    v_rcp_f32 v131, v131
    v_pk_fma_f32 v[108:109], v[108:109], s[58:59], s[58:59] clamp
    s_waitcnt vmcnt(4)
    v_pk_fma_f32 v[110:111], v[110:111], s[58:59], s[58:59] clamp
    ds_read_b128 v[132:135], v14 offset:0
    v_pk_fma_f32 v[112:113], v[112:113], s[58:59], s[58:59] clamp
    ds_read_b128 v[136:139], v15 offset:0
    v_pk_fma_f32 v[114:115], v[114:115], s[58:59], s[58:59] clamp
    ds_read_b64_tr_b16 v[32:33], v10
    v_pk_fma_f32 v[116:117], v[116:117], s[58:59], s[58:59] clamp
    ds_read_b128 v[26:29], v5 offset:1536
    v_pk_fma_f32 v[118:119], v[118:119], s[58:59], s[58:59] clamp
    s_add_u32 m0, s53, 8192
    v_pk_fma_f32 v[120:121], v[120:121], s[58:59], s[58:59] clamp
    v_pk_fma_f32 v[122:123], v[122:123], s[58:59], s[58:59] clamp
    buffer_load_dwordx4 v[18:19], s[20:23], 0 idxen offen offset:0 lds
    v_pk_mul_f32 v[124:125], v[124:125], v[128:129]
    v_pk_mul_f32 v[126:127], v[126:127], v[130:131]
    v_pk_mul_f32 v[76:77], v[76:77], v[110:111]
    v_pk_mul_f32 v[80:81], v[80:81], v[114:115]
    v_pk_mul_f32 v[84:85], v[84:85], v[118:119]
    v_pk_mul_f32 v[88:89], v[88:89], v[122:123]
    v_cvt_pk_bf16_f32 v160, v124, v125
    buffer_load_dwordx4 v[20:21], s[20:23], 0 idxen offen offset:1024 lds
    v_cvt_pk_bf16_f32 v161, v126, v127
    v_pk_fma_f32 v[76:77], v[78:79], v[108:109], v[76:77]
    v_pk_fma_f32 v[80:81], v[82:83], v[112:113], v[80:81]
    v_pk_fma_f32 v[84:85], v[86:87], v[116:117], v[84:85]
    v_pk_fma_f32 v[88:89], v[90:91], v[120:121], v[88:89]
    v_pk_mul_f32 v[108:109], v[108:109], v[110:111]
    v_pk_mul_f32 v[112:113], v[112:113], v[114:115]
    buffer_load_dwordx4 v[22:23], s[20:23], 0 idxen offen offset:2048 lds
    v_pk_mul_f32 v[116:117], v[116:117], v[118:119]
    v_pk_mul_f32 v[120:121], v[120:121], v[122:123]
    v_pk_mul_f32 v[124:125], v[76:77], v[112:113]
    v_pk_mul_f32 v[126:127], v[84:85], v[120:121]
    v_pk_mul_f32 v[128:129], v[108:109], v[112:113]
    v_pk_mul_f32 v[130:131], v[116:117], v[120:121]
    v_pk_fma_f32 v[124:125], v[80:81], v[108:109], v[124:125]
    buffer_load_dwordx4 v[24:25], s[20:23], 0 idxen offen offset:3072 lds
    v_pk_fma_f32 v[126:127], v[88:89], v[116:117], v[126:127]
    s_waitcnt lgkmcnt(0)
    v_mfma_f32_32x32x8_bf16 v[60:75], v[160:161], v[164:165], v[60:75]
    v_exp_f32 v108, v92
    v_exp_f32 v109, v93
    v_exp_f32 v110, v94
    v_exp_f32 v111, v95
    v_exp_f32 v112, v96
    v_mfma_f32_32x32x16_bf16 v[76:91], v[26:29], v[30:33], 0
    v_exp_f32 v113, v97
    v_exp_f32 v114, v98
    v_exp_f32 v115, v99
    v_exp_f32 v116, v100
    v_exp_f32 v117, v101
    v_mfma_f32_32x32x16_bf16 v[76:91], v[132:135], v[148:151], v[76:91]
    v_exp_f32 v118, v102
    v_exp_f32 v119, v103
    v_exp_f32 v120, v104
    v_exp_f32 v121, v105
    v_exp_f32 v122, v106
    v_mfma_f32_32x32x16_bf16 v[76:91], v[136:139], v[152:155], v[76:91]
    v_exp_f32 v123, v107
    v_rcp_f32 v128, v128
    v_rcp_f32 v129, v129
    v_rcp_f32 v130, v130
    v_rcp_f32 v131, v131
    v_pk_fma_f32 v[108:109], v[108:109], s[58:59], s[58:59] clamp
    ds_read_b128 v[140:143], v16 offset:0
    v_pk_fma_f32 v[110:111], v[110:111], s[58:59], s[58:59] clamp
    v_pk_fma_f32 v[112:113], v[112:113], s[58:59], s[58:59] clamp
    ds_read_b128 v[144:147], v17 offset:0
    v_pk_fma_f32 v[114:115], v[114:115], s[58:59], s[58:59] clamp
    v_pk_fma_f32 v[116:117], v[116:117], s[58:59], s[58:59] clamp
    ds_read_b64_tr_b16 v[36:37], v10 offset:64
    v_pk_fma_f32 v[118:119], v[118:119], s[58:59], s[58:59] clamp
    v_pk_fma_f32 v[120:121], v[120:121], s[58:59], s[58:59] clamp
    ds_read_b64_tr_b16 v[164:165], v13
    v_pk_fma_f32 v[122:123], v[122:123], s[58:59], s[58:59] clamp
    v_pk_mul_f32 v[124:125], v[124:125], v[128:129]
    ds_read_u8 v9, v6 offset:32
    v_pk_mul_f32 v[126:127], v[126:127], v[130:131]
    v_pk_mul_f32 v[92:93], v[92:93], v[110:111]
    ds_read_u16 v18, v4 offset:384
    v_pk_mul_f32 v[96:97], v[96:97], v[114:115]
    v_pk_mul_f32 v[100:101], v[100:101], v[118:119]
    ds_read_u16 v20, v4 offset:388
    v_pk_mul_f32 v[104:105], v[104:105], v[122:123]
    v_cvt_pk_bf16_f32 v156, v124, v125
    ds_read_u16 v22, v4 offset:400
    v_cvt_pk_bf16_f32 v157, v126, v127
    v_pk_fma_f32 v[92:93], v[94:95], v[108:109], v[92:93]
    ds_read_u16 v24, v4 offset:404
    v_pk_fma_f32 v[96:97], v[98:99], v[112:113], v[96:97]
    v_pk_fma_f32 v[100:101], v[102:103], v[116:117], v[100:101]
    v_pk_fma_f32 v[104:105], v[106:107], v[120:121], v[104:105]
    v_pk_mul_f32 v[108:109], v[108:109], v[110:111]
    v_pk_mul_f32 v[112:113], v[112:113], v[114:115]
    v_pk_mul_f32 v[116:117], v[116:117], v[118:119]
    v_pk_mul_f32 v[120:121], v[120:121], v[122:123]
    v_pk_mul_f32 v[124:125], v[92:93], v[112:113]
    v_pk_mul_f32 v[126:127], v[100:101], v[120:121]
    v_pk_mul_f32 v[128:129], v[108:109], v[112:113]
    v_pk_mul_f32 v[130:131], v[116:117], v[120:121]
    v_pk_fma_f32 v[124:125], v[96:97], v[108:109], v[124:125]
    v_add_u32 v4, 192, v4
    v_add_u32 v5, v8, v5
    v_add_u32 v6, 24, v6
    s_sub_u32 s54, s54, 1
    v_pk_fma_f32 v[126:127], v[104:105], v[116:117], v[126:127]
    s_cbranch_scc1 k2_drain
    s_waitcnt lgkmcnt(0)
    v_mfma_f32_32x32x8_bf16 v[44:59], v[156:157], v[164:165], v[44:59]
    v_exp_f32 v108, v76
    v_exp_f32 v109, v77
    v_exp_f32 v110, v78
    v_exp_f32 v111, v79
    v_exp_f32 v112, v80
    v_mfma_f32_32x32x16_bf16 v[92:107], v[26:29], v[34:37], 0
    v_exp_f32 v113, v81
    v_exp_f32 v114, v82
    v_exp_f32 v115, v83
    v_exp_f32 v116, v84
    v_exp_f32 v117, v85
    v_mfma_f32_32x32x16_bf16 v[92:107], v[140:143], v[148:151], v[92:107]
    v_exp_f32 v118, v86
    v_exp_f32 v119, v87
    v_exp_f32 v120, v88
    v_exp_f32 v121, v89
    v_exp_f32 v122, v90
    v_mfma_f32_32x32x16_bf16 v[92:107], v[144:147], v[152:155], v[92:107]
    v_mad_u32_u24 v10, v9, s68, v7
    v_add_u32 v12, s69, v10
    v_exp_f32 v123, v91
    v_rcp_f32 v128, v128
    v_rcp_f32 v129, v129
    v_rcp_f32 v130, v130
    v_rcp_f32 v131, v131
    v_pk_fma_f32 v[108:109], v[108:109], s[58:59], s[58:59] clamp
    s_waitcnt vmcnt(4)
    v_pk_fma_f32 v[110:111], v[110:111], s[58:59], s[58:59] clamp
    ds_read_b128 v[132:135], v14 offset:4096
    v_pk_fma_f32 v[112:113], v[112:113], s[58:59], s[58:59] clamp
    ds_read_b128 v[136:139], v15 offset:4096
    v_pk_fma_f32 v[114:115], v[114:115], s[58:59], s[58:59] clamp
    ds_read_b64_tr_b16 v[32:33], v10
    v_pk_fma_f32 v[116:117], v[116:117], s[58:59], s[58:59] clamp
    ds_read_b128 v[26:29], v5 offset:512
    v_pk_fma_f32 v[118:119], v[118:119], s[58:59], s[58:59] clamp
    s_add_u32 m0, s53, 0
    v_pk_fma_f32 v[120:121], v[120:121], s[58:59], s[58:59] clamp
    v_pk_fma_f32 v[122:123], v[122:123], s[58:59], s[58:59] clamp
    buffer_load_dwordx4 v[18:19], s[20:23], 0 idxen offen offset:0 lds
    v_pk_mul_f32 v[124:125], v[124:125], v[128:129]
    v_pk_mul_f32 v[126:127], v[126:127], v[130:131]
    v_pk_mul_f32 v[76:77], v[76:77], v[110:111]
    v_pk_mul_f32 v[80:81], v[80:81], v[114:115]
    v_pk_mul_f32 v[84:85], v[84:85], v[118:119]
    v_pk_mul_f32 v[88:89], v[88:89], v[122:123]
    v_cvt_pk_bf16_f32 v160, v124, v125
    buffer_load_dwordx4 v[20:21], s[20:23], 0 idxen offen offset:1024 lds
    v_cvt_pk_bf16_f32 v161, v126, v127
    v_pk_fma_f32 v[76:77], v[78:79], v[108:109], v[76:77]
    v_pk_fma_f32 v[80:81], v[82:83], v[112:113], v[80:81]
    v_pk_fma_f32 v[84:85], v[86:87], v[116:117], v[84:85]
    v_pk_fma_f32 v[88:89], v[90:91], v[120:121], v[88:89]
    v_pk_mul_f32 v[108:109], v[108:109], v[110:111]
    v_pk_mul_f32 v[112:113], v[112:113], v[114:115]
    buffer_load_dwordx4 v[22:23], s[20:23], 0 idxen offen offset:2048 lds
    v_pk_mul_f32 v[116:117], v[116:117], v[118:119]
    v_pk_mul_f32 v[120:121], v[120:121], v[122:123]
    v_pk_mul_f32 v[124:125], v[76:77], v[112:113]
    v_pk_mul_f32 v[126:127], v[84:85], v[120:121]
    v_pk_mul_f32 v[128:129], v[108:109], v[112:113]
    v_pk_mul_f32 v[130:131], v[116:117], v[120:121]
    v_pk_fma_f32 v[124:125], v[80:81], v[108:109], v[124:125]
    buffer_load_dwordx4 v[24:25], s[20:23], 0 idxen offen offset:3072 lds
    v_pk_fma_f32 v[126:127], v[88:89], v[116:117], v[126:127]
    s_waitcnt lgkmcnt(0)
    v_mfma_f32_32x32x8_bf16 v[60:75], v[160:161], v[164:165], v[60:75]
    v_exp_f32 v108, v92
    v_exp_f32 v109, v93
    v_exp_f32 v110, v94
    v_exp_f32 v111, v95
    v_exp_f32 v112, v96
    v_mfma_f32_32x32x16_bf16 v[76:91], v[26:29], v[30:33], 0
    v_exp_f32 v113, v97
    v_exp_f32 v114, v98
    v_exp_f32 v115, v99
    v_exp_f32 v116, v100
    v_exp_f32 v117, v101
    v_mfma_f32_32x32x16_bf16 v[76:91], v[132:135], v[148:151], v[76:91]
    v_exp_f32 v118, v102
    v_exp_f32 v119, v103
    v_exp_f32 v120, v104
    v_exp_f32 v121, v105
    v_exp_f32 v122, v106
    v_mfma_f32_32x32x16_bf16 v[76:91], v[136:139], v[152:155], v[76:91]
    v_exp_f32 v123, v107
    v_rcp_f32 v128, v128
    v_rcp_f32 v129, v129
    v_rcp_f32 v130, v130
    v_rcp_f32 v131, v131
    v_pk_fma_f32 v[108:109], v[108:109], s[58:59], s[58:59] clamp
    ds_read_b128 v[140:143], v16 offset:4096
    v_pk_fma_f32 v[110:111], v[110:111], s[58:59], s[58:59] clamp
    v_pk_fma_f32 v[112:113], v[112:113], s[58:59], s[58:59] clamp
    ds_read_b128 v[144:147], v17 offset:4096
    v_pk_fma_f32 v[114:115], v[114:115], s[58:59], s[58:59] clamp
    v_pk_fma_f32 v[116:117], v[116:117], s[58:59], s[58:59] clamp
    ds_read_b64_tr_b16 v[36:37], v10 offset:64
    v_pk_fma_f32 v[118:119], v[118:119], s[58:59], s[58:59] clamp
    v_pk_fma_f32 v[120:121], v[120:121], s[58:59], s[58:59] clamp
    ds_read_b64_tr_b16 v[164:165], v11
    v_pk_fma_f32 v[122:123], v[122:123], s[58:59], s[58:59] clamp
    v_pk_mul_f32 v[124:125], v[124:125], v[128:129]
    ds_read_u8 v9, v6 offset:16
    v_pk_mul_f32 v[126:127], v[126:127], v[130:131]
    v_pk_mul_f32 v[92:93], v[92:93], v[110:111]
    ds_read_u16 v18, v4 offset:256
    v_pk_mul_f32 v[96:97], v[96:97], v[114:115]
    v_pk_mul_f32 v[100:101], v[100:101], v[118:119]
    ds_read_u16 v20, v4 offset:260
    v_pk_mul_f32 v[104:105], v[104:105], v[122:123]
    v_cvt_pk_bf16_f32 v156, v124, v125
    ds_read_u16 v22, v4 offset:272
    v_cvt_pk_bf16_f32 v157, v126, v127
    v_pk_fma_f32 v[92:93], v[94:95], v[108:109], v[92:93]
    ds_read_u16 v24, v4 offset:276
    v_pk_fma_f32 v[96:97], v[98:99], v[112:113], v[96:97]
    v_pk_fma_f32 v[100:101], v[102:103], v[116:117], v[100:101]
    v_pk_fma_f32 v[104:105], v[106:107], v[120:121], v[104:105]
    v_pk_mul_f32 v[108:109], v[108:109], v[110:111]
    v_pk_mul_f32 v[112:113], v[112:113], v[114:115]
    v_pk_mul_f32 v[116:117], v[116:117], v[118:119]
    v_pk_mul_f32 v[120:121], v[120:121], v[122:123]
    v_pk_mul_f32 v[124:125], v[92:93], v[112:113]
    v_pk_mul_f32 v[126:127], v[100:101], v[120:121]
    v_pk_mul_f32 v[128:129], v[108:109], v[112:113]
    v_pk_mul_f32 v[130:131], v[116:117], v[120:121]
    v_pk_fma_f32 v[124:125], v[96:97], v[108:109], v[124:125]
    s_sub_u32 s54, s54, 1
    v_pk_fma_f32 v[126:127], v[104:105], v[116:117], v[126:127]
    s_cbranch_scc0 k2_loopS
    s_branch k2_drain
.section .rodata,"a"
.p2align 6
.amdhsa_kernel standalone__mpnn_edge_mlp__graph_kernel
  .amdhsa_next_free_vgpr 256
  .amdhsa_next_free_sgpr 102
  .amdhsa_accum_offset 256
  .amdhsa_group_segment_fixed_size 0
  .amdhsa_kernarg_size 72
  .amdhsa_user_sgpr_count 2
  .amdhsa_user_sgpr_kernarg_segment_ptr 1
  .amdhsa_system_sgpr_workgroup_id_x 1
.end_amdhsa_kernel
```
